```python
import torch

def _softmax(x, axis=-1):
    return torch.softmax(x, dim=axis)

def _gelu(x):
    return torch.nn.functional.gelu(x, approximate='tanh')

def _silu(x):
    return torch.nn.functional.silu(x)

def _sigmoid(x):
    return torch.sigmoid(x)

def _layernorm(x, axis=-1, eps=1e-05):
    m = x.mean(dim=axis, keepdim=True)
    v = x.var(dim=axis, keepdim=True, unbiased=False)
    return (x - m) / torch.sqrt(v + eps)

def _scatter_add(tgt, idx, src, axis=0):
    return tgt.clone().index_add_(axis, idx, src)

def _segment_sum(src, seg, n):
    out = torch.zeros((n,) + src.shape[1:], dtype=src.dtype)
    return out.index_add_(0, seg, src)

def _pad(x, pw):
    flat = tuple((v for pair in reversed(pw) for v in pair))
    return torch.nn.functional.pad(x, flat)
kernel_name = 'standalone__video_timesformer__vision'

def setup_inputs():

    _w = lambda a: (lambda t: t.to(torch.bfloat16) if t.is_floating_point() else t)(torch.as_tensor(a))
    T = 8
    p = 16
    HW = 512 // p * p
    N = (HW // p) ** 2
    C = 192
    return {'x': _w((lambda *s: torch.randn(*s, dtype=torch.bfloat16) * 0.1)(1, T, N, C)), 'wqkv_t': _w((lambda *s: torch.randn(*s, dtype=torch.bfloat16) * 0.1)(C, 3 * C)), 'wo_t': _w((lambda *s: torch.randn(*s, dtype=torch.bfloat16) * 0.1)(C, C)), 'wqkv_s': _w((lambda *s: torch.randn(*s, dtype=torch.bfloat16) * 0.1)(C, 3 * C)), 'wo_s': _w((lambda *s: torch.randn(*s, dtype=torch.bfloat16) * 0.05)(C, C))}

def reference(x, wqkv_t, wo_t, wqkv_s, wo_s):
    B, T, N, C = x.shape
    scale = C ** (-0.5)
    xt = (lambda x, *d: x.permute(*d))(x, 0, 2, 1, 3).reshape(B * N, T, C)
    h = _layernorm(xt, axis=-1)
    qkv = h @ wqkv_t
    q, k, v = (qkv[..., :C].clone(), qkv[..., C:2 * C].clone(), qkv[..., 2 * C:].clone())
    a = _softmax(torch.einsum('btc,bsc->bts', q, k) * scale, axis=-1)
    xt = xt + torch.einsum('bts,bsc->btc', a, v) @ wo_t
    x1 = (lambda x, *d: x.permute(*d))(xt.reshape(B, N, T, C), 0, 2, 1, 3)
    xs = x1.reshape(B * T, N, C)
    h = _layernorm(xs, axis=-1)
    qkv = h @ wqkv_s
    q, k, v = (qkv[..., :C].clone(), qkv[..., C:2 * C].clone(), qkv[..., 2 * C:].clone())
    a = _softmax(torch.einsum('bnc,bmc->bnm', q, k) * scale, axis=-1)
    xs = xs + torch.einsum('bnm,bmc->bnc', a, v) @ wo_s
    return xs.reshape(B, T, N, C)
```

```asm
; @launch kernel=standalone__video_timesformer__vision_kernel grid=(256,1,1) block=(256,1,1) lds=163840
.amdgcn_target "amdgcn-amd-amdhsa--gfx950"
.text
.globl standalone__video_timesformer__vision_kernel
.p2align 8
.type standalone__video_timesformer__vision_kernel,@function
standalone__video_timesformer__vision_kernel:
  s_cmp_ge_u32 s2, 256
  s_cbranch_scc1 ts_b_end
  s_load_dwordx2 s[24:25], s[0:1], 0
  s_load_dwordx2 s[8:9], s[0:1], 8
  s_load_dwordx2 s[12:13], s[0:1], 16
  s_load_dwordx2 s[16:17], s[0:1], 24
  s_load_dwordx2 s[20:21], s[0:1], 32
  s_load_dwordx2 s[4:5], s[0:1], 56
  v_and_b32 v1, 63, v0
  v_lshrrev_b32 v54, 6, v0
  s_nop 0
  v_readfirstlane_b32 s28, v54
  s_mov_b32 s26, 3145728
  s_mov_b32 s27, 0x00020000
  s_mov_b32 s10, 221184
  s_mov_b32 s11, 0x00020000
  s_mov_b32 s14, 73728
  s_mov_b32 s15, 0x00020000
  s_mov_b32 s18, 221184
  s_mov_b32 s19, 0x00020000
  s_mov_b32 s22, 73728
  s_mov_b32 s23, 0x00020000
  s_mov_b32 s6, 268435456
  s_mov_b32 s7, 0x00020000
  v_lshrrev_b32 v52, 3, v1
  v_and_b32 v53, 7, v1
  v_mul_u32_u24 v54, 393216, v52
  v_lshl_add_u32 v2, v53, 4, v54
  s_lshl_b32 s33, s2, 2
  s_add_u32 s33, s33, s28
  s_mul_i32 s29, s33, 384
  s_lshl_b32 s44, s33, 3
  s_add_u32 s44, s44, 3407872
  s_and_b32 s34, s28, 1
  s_lshl_b32 s34, s34, 2
  v_and_b32 v54, 2, v52
  v_xor_b32 v54, v54, v53
  v_xor_b32 v54, s34, v54
  v_lshlrev_b32 v54, 4, v54
  v_mul_u32_u24 v55, 1152, v52
  v_add_u32 v4, v54, v55
  v_mul_u32_u24 v55, 384, v52
  v_add_u32 v5, v54, v55
  v_add_u32 v6, 2048, v4
  v_add_u32 v7, 1152, v4
  v_add_u32 v8, 256, v4
  s_mul_i32 s30, s28, 9216
  s_mul_i32 s31, s28, 3072
  s_mul_i32 s32, s28, 3072
  s_sub_u32 s33, s2, 2
  s_and_b32 s33, s33, 7
  s_lshr_b32 s34, s2, 3
  s_mul_i32 s35, s34, 5
  s_add_u32 s35, s35, s33
  s_cmp_ge_u32 s33, 5
  s_cselect_b32 s35, 255, s35
  s_cmp_lt_u32 s28, 3
  s_cselect_b32 s35, 255, s35
  s_cmp_lt_u32 s35, 144
  s_cselect_b32 s99, 1, 0
  s_sub_u32 s33, s2, 0
  s_and_b32 s33, s33, 7
  s_sub_u32 s34, s34, 0
  s_mul_i32 s3, s34, 2
  s_add_u32 s3, s3, s33
  s_cmp_ge_u32 s33, 2
  s_cselect_b32 s3, 255, s3
  s_cmp_lt_u32 s3, 36
  s_cselect_b32 s33, 2, 0
  s_or_b32 s99, s99, s33
  s_mov_b32 s41, s35
  s_mul_i32 s34, s41, 171
  s_lshr_b32 s34, s34, 11
  s_mul_i32 s35, s34, 12
  s_sub_u32 s35, s41, s35
  s_mul_i32 s38, s35, 18432
  s_mul_i32 s39, s34, 18432
  s_add_u32 s39, s39, 384
  s_mul_i32 s40, s34, 6144
  s_lshl_b32 s35, s35, 9
  s_add_u32 s40, s40, s35
  s_add_u32 s40, s40, 3145728
  s_min_u32 s35, s41, 127
  s_mul_i32 s35, s35, 512
  s_add_u32 s35, s35, 3670016
  v_mul_u32_u24 v66, 256, v1
  v_add_u32 v66, s35, v66
  v_mov_b32 v68, 0
  s_mul_i32 s41, s41, 16
  s_add_u32 s41, s41, 3473664
  v_and_b32 v49, 15, v1
  v_lshrrev_b32 v48, 4, v1
  v_mul_u32_u24 v54, 1152, v49
  v_lshl_add_u32 v41, v48, 4, v54
  v_min_u32 v55, 2, v48
  v_lshl_add_u32 v42, v55, 7, v54
  v_lshrrev_b32 v54, 1, v48
  v_lshl_add_u32 v54, v54, 4, v49
  v_lshlrev_b32 v54, 4, v54
  v_and_b32 v55, 1, v48
  v_lshl_add_u32 v67, v55, 3, v54
  s_mul_i32 s33, s3, 171
  s_lshr_b32 s33, s33, 10
  s_mul_i32 s34, s33, 6
  s_sub_u32 s34, s3, s34
  s_mul_i32 s36, s33, 36864
  s_add_u32 s36, s36, 768
  s_add_u32 s36, s36, s30
  s_mul_i32 s37, s28, 18432
  s_lshl_b32 s34, s34, 6
  s_add_u32 s37, s37, s34
  v_lshrrev_b32 v54, 2, v1
  v_mul_u32_u24 v54, 384, v54
  v_and_b32 v55, 3, v1
  v_lshl_add_u32 v30, v55, 4, v54
  v_xor_b32 v54, v53, v52
  v_lshlrev_b32 v54, 4, v54
  v_mul_u32_u24 v55, 1152, v52
  v_add_u32 v29, v54, v55
  v_min_u32 v54, 2, v53
  v_lshl_add_u32 v64, v54, 7, v55
  v_min_u32 v54, 47, v1
  v_mul_u32_u24 v65, 384, v54
  s_lshr_b32 s34, s2, 3
  s_and_b32 s34, s34, 31
  s_mul_i32 s35, s28, 14
  s_add_u32 m0, s32, 0
  s_add_u32 s42, s30, 0
  s_waitcnt lgkmcnt(0)
  s_mov_b32 s47, 3473408
  s_load_dword s98, s[4:5], s47
  buffer_load_dwordx4 v[80:83], v2, s[24:27], s29 offen offset:0
  buffer_load_dwordx4 v[84:87], v2, s[24:27], s29 offen offset:128
  buffer_load_dwordx4 v[88:91], v2, s[24:27], s29 offen offset:256
  s_bitcmp1_b32 s99, 0
  s_cbranch_scc0 standalone__video_timesformer__vision_kernel_tm
  buffer_load_dword v32, v42, s[16:19], s38 offen
  buffer_load_dword v32, v42, s[16:19], s39 offen
standalone__video_timesformer__vision_kernel_tm:
  s_bitcmp1_b32 s99, 1
  s_cbranch_scc0 standalone__video_timesformer__vision_kernel_tw
  buffer_load_dword v32, v64, s[16:19], s36 offen
  buffer_load_dword v32, v65, s[20:23], s37 offen
standalone__video_timesformer__vision_kernel_tw:
  buffer_load_dwordx4 v4, s[8:11], s42 offen offset:0 lds
  s_add_u32 m0, m0, 896
  s_nop 0
  buffer_load_dwordx4 v4, s[8:11], s42 offen offset:128 lds
  s_add_u32 m0, m0, 896
  s_nop 0
  buffer_load_dwordx4 v4, s[8:11], s42 offen offset:256 lds
  s_add_u32 m0, s32, 12288
  s_add_u32 s42, s30, 34816
  buffer_load_dwordx4 v6, s[8:11], s42 offen offset:0 lds
  buffer_load_dwordx4 v7, s[8:11], s42 offen offset:1024 lds
  buffer_load_dwordx4 v8, s[8:11], s42 offen offset:2048 lds
  s_add_u32 m0, s32, 24576
  s_add_u32 s42, s30, 71680
  v_min_u32 v54, 13, v1
  v_add_u32 v54, s35, v54
  v_min_u32 v54, 53, v54
  s_mul_i32 s35, s34, 54
  v_add_u32 v54, s35, v54
  v_lshlrev_b32 v34, 7, v54
  s_mul_i32 s35, s28, 5
  v_min_u32 v54, 4, v1
  v_add_u32 v54, s35, v54
  v_min_u32 v54, 17, v54
  s_mul_i32 s35, s34, 18
  v_add_u32 v54, s35, v54
  v_lshlrev_b32 v35, 7, v54
  v_add_u32 v9, 2048, v5
  v_add_u32 v10, 1152, v5
  v_add_u32 v11, 256, v5
  v_lshrrev_b32 v48, 4, v1
  v_and_b32 v49, 15, v1
  v_bfe_u32 v50, v1, 2, 2
  v_and_b32 v51, 3, v1
  s_mul_i32 s33, s28, 3072
  s_add_u32 s33, s33, 135168
  v_xor_b32 v54, v53, v52
  v_lshlrev_b32 v54, 4, v54
  v_mul_u32_u24 v55, 384, v52
  v_add3_u32 v21, v54, v55, s33
  v_mov_b32 v31, 0x3f803f80
  v_mul_u32_u24 v54, 3072, v48
  v_lshl_add_u32 v54, v50, 7, v54
  v_bfe_u32 v55, v1, 2, 3
  v_and_b32 v55, 6, v55
  v_bfe_u32 v56, v1, 1, 1
  v_or_b32 v55, v55, v56
  v_lshl_add_u32 v54, v55, 4, v54
  v_and_b32 v55, 1, v1
  v_lshl_add_u32 v54, v55, 3, v54
  s_mul_i32 s33, s28, 3
  s_add_u32 s33, s33, 0
  s_and_b32 s34, s33, 3
  s_lshl_b32 s34, s34, 5
  s_lshr_b32 s35, s33, 2
  s_lshl_b32 s35, s35, 10
  v_xor_b32 v12, s34, v54
  v_add_u32 v12, s35, v12
  v_add_u32 v15, 49152, v12
  v_add_u32 v18, 98304, v12
  s_mul_i32 s33, s28, 3
  s_add_u32 s33, s33, 1
  s_and_b32 s34, s33, 3
  s_lshl_b32 s34, s34, 5
  s_lshr_b32 s35, s33, 2
  s_lshl_b32 s35, s35, 10
  v_xor_b32 v13, s34, v54
  v_add_u32 v13, s35, v13
  v_add_u32 v16, 49152, v13
  v_add_u32 v19, 98304, v13
  s_mul_i32 s33, s28, 3
  s_add_u32 s33, s33, 2
  s_and_b32 s34, s33, 3
  s_lshl_b32 s34, s34, 5
  s_lshr_b32 s35, s33, 2
  s_lshl_b32 s35, s35, 10
  v_xor_b32 v14, s34, v54
  v_add_u32 v14, s35, v14
  v_add_u32 v17, 49152, v14
  v_add_u32 v20, 98304, v14
  v_and_b32 v56, 7, v49
  v_xor_b32 v54, v48, v56
  v_lshlrev_b32 v54, 4, v54
  v_mul_u32_u24 v55, 384, v49
  v_add_u32 v55, 135168, v55
  v_add_u32 v22, v54, v55
  v_xor_b32 v23, 64, v22
  s_mul_i32 s33, s28, 6
  s_add_u32 s33, s33, 0
  v_lshrrev_b32 v54, 1, v48
  v_add_u32 v54, s33, v54
  v_and_b32 v24, 7, v54
  v_xor_b32 v24, v24, v56
  v_lshl_add_u32 v24, v24, 4, v55
  v_lshrrev_b32 v54, 3, v54
  v_lshl_add_u32 v24, v54, 7, v24
  v_and_b32 v54, 1, v48
  v_lshl_add_u32 v24, v54, 3, v24
  s_mul_i32 s33, s28, 6
  s_add_u32 s33, s33, 2
  v_lshrrev_b32 v54, 1, v48
  v_add_u32 v54, s33, v54
  v_and_b32 v25, 7, v54
  v_xor_b32 v25, v25, v56
  v_lshl_add_u32 v25, v25, 4, v55
  v_lshrrev_b32 v54, 3, v54
  v_lshl_add_u32 v25, v54, 7, v25
  v_and_b32 v54, 1, v48
  v_lshl_add_u32 v25, v54, 3, v25
  s_mul_i32 s33, s28, 6
  s_add_u32 s33, s33, 4
  v_lshrrev_b32 v54, 1, v48
  v_add_u32 v54, s33, v54
  v_and_b32 v26, 7, v54
  v_xor_b32 v26, v26, v56
  v_lshl_add_u32 v26, v26, 4, v55
  v_lshrrev_b32 v54, 3, v54
  v_lshl_add_u32 v26, v54, 7, v26
  v_and_b32 v54, 1, v48
  v_lshl_add_u32 v26, v54, 3, v26
  v_lshlrev_b32 v54, 4, v1
  v_add_u32 v27, 135168, v54
  s_lshl_b32 s33, s28, 11
  v_add_u32 v28, s33, v27
  s_lshr_b32 s33, s28, 1
  s_lshl_b32 s33, s33, 2
  s_and_b32 s34, s2, 3
  s_or_b32 s33, s33, s34
  v_xor_b32 v54, s33, v53
  v_mul_u32_u24 v55, 393216, v52
  v_lshl_add_u32 v3, v54, 4, v55
  s_lshr_b32 s43, s2, 3
  s_mul_i32 s43, s43, 12288
  s_and_b32 s35, s2, 7
  s_lshl_b32 s35, s35, 2
  s_add_u32 s35, s35, s28
  s_lshl_b32 s35, s35, 7
  s_add_u32 s43, s43, s35
  v_lshlrev_b32 v33, 13, v52
  v_lshrrev_b32 v54, 3, v49
  v_lshrrev_b32 v55, 1, v48
  v_cmp_eq_u32 s[100:101], v54, v55
  v_lshlrev_b32 v36, 4, v1
  s_mul_i32 s33, s28, 36
  v_min_u32 v40, 35, v1
  v_add_u32 v40, s33, v40
  v_mul_u32_u24 v40, 16, v40
  v_add_u32 v40, 3473664, v40
  v_mov_b32 v46, 0
  v_mov_b32 v44, 0
  v_mov_b32 v48, 0
  v_mov_b32 v49, 0
  s_cmp_lg_u32 s99, 0
  s_cbranch_scc1 WR_1
  s_waitcnt vmcnt(6)
WR_1:
  s_waitcnt vmcnt(8)
  buffer_load_dword v32, v34, s[8:11], 0 offen
  buffer_load_dword v32, v35, s[12:15], 0 offen
  buffer_load_dwordx4 v6, s[8:11], s42 offen offset:0 lds
  buffer_load_dwordx4 v7, s[8:11], s42 offen offset:1024 lds
  buffer_load_dwordx4 v8, s[8:11], s42 offen offset:2048 lds
  s_add_u32 m0, s32, 36864
  s_add_u32 s42, s30, 108544
  buffer_load_dwordx4 v6, s[8:11], s42 offen offset:0 lds
  v_dot2c_f32_bf16 v46, v80, v31
  v_dot2c_f32_bf16 v44, v80, v80
  ds_write_b128 v21, v[80:83] offset:16384
  v_dot2c_f32_bf16 v48, v81, v31
  v_dot2c_f32_bf16 v49, v81, v81
  v_dot2c_f32_bf16 v46, v82, v31
  v_dot2c_f32_bf16 v44, v82, v82
  v_dot2c_f32_bf16 v48, v83, v31
  v_dot2c_f32_bf16 v49, v83, v83
  v_dot2c_f32_bf16 v46, v84, v31
  v_dot2c_f32_bf16 v44, v84, v84
  ds_write_b128 v21, v[84:87] offset:16512
  v_dot2c_f32_bf16 v48, v85, v31
  v_dot2c_f32_bf16 v49, v85, v85
  v_dot2c_f32_bf16 v46, v86, v31
  v_dot2c_f32_bf16 v44, v86, v86
  v_dot2c_f32_bf16 v48, v87, v31
  v_dot2c_f32_bf16 v49, v87, v87
  v_dot2c_f32_bf16 v46, v88, v31
  v_dot2c_f32_bf16 v44, v88, v88
  ds_write_b128 v21, v[88:91] offset:16640
  v_dot2c_f32_bf16 v48, v89, v31
  v_dot2c_f32_bf16 v49, v89, v89
  v_dot2c_f32_bf16 v46, v90, v31
  v_dot2c_f32_bf16 v44, v90, v90
  v_dot2c_f32_bf16 v48, v91, v31
  v_dot2c_f32_bf16 v49, v91, v91
  s_nop 1
  v_add_f32 v46, v46, v48
  v_add_f32 v44, v44, v49
  s_nop 0
  v_add_f32_dpp v46, v46, v46 quad_perm:[1,0,3,2] row_mask:0xf bank_mask:0xf
  v_add_f32_dpp v44, v44, v44 quad_perm:[1,0,3,2] row_mask:0xf bank_mask:0xf
  buffer_load_dwordx4 v7, s[8:11], s42 offen offset:1024 lds
  v_add_f32_dpp v46, v46, v46 quad_perm:[2,3,0,1] row_mask:0xf bank_mask:0xf
  v_add_f32_dpp v44, v44, v44 quad_perm:[2,3,0,1] row_mask:0xf bank_mask:0xf
  s_nop 0
  v_add_f32_dpp v46, v46, v46 row_half_mirror row_mask:0xf bank_mask:0xf
  v_add_f32_dpp v44, v44, v44 row_half_mirror row_mask:0xf bank_mask:0xf
  v_mul_f32 v46, 0x3baaaaab, v46
  v_mov_b32 v49, 0x3727c5ac
  v_fmac_f32 v49, 0x3baaaaab, v44
  v_mul_f32 v48, v46, v46
  v_sub_f32 v44, v49, v48
  v_max_f32 v44, 0x3727c5ac, v44
  v_rsq_f32 v44, v44
  s_nop 0
  v_mul_f32 v46, v46, v44
  v_sub_f32 v46, 0, v46
  v_lshlrev_b32 v50, 16, v80
  v_and_b32 v51, 0xffff0000, v80
  v_pk_fma_f32 v[50:51], v[50:51], v[44:45], v[46:47] op_sel_hi:[1,0,0]
  buffer_load_dwordx4 v8, s[8:11], s42 offen offset:2048 lds
  s_add_u32 m0, s32, 49152
  s_add_u32 s42, s30, 145408
  v_cvt_pk_bf16_f32 v92, v50, v51
  v_lshlrev_b32 v52, 16, v81
  v_and_b32 v53, 0xffff0000, v81
  v_pk_fma_f32 v[52:53], v[52:53], v[44:45], v[46:47] op_sel_hi:[1,0,0]
  v_cvt_pk_bf16_f32 v93, v52, v53
  v_lshlrev_b32 v50, 16, v82
  v_and_b32 v51, 0xffff0000, v82
  v_pk_fma_f32 v[50:51], v[50:51], v[44:45], v[46:47] op_sel_hi:[1,0,0]
  v_cvt_pk_bf16_f32 v94, v50, v51
  v_lshlrev_b32 v52, 16, v83
  v_and_b32 v53, 0xffff0000, v83
  v_pk_fma_f32 v[52:53], v[52:53], v[44:45], v[46:47] op_sel_hi:[1,0,0]
  v_cvt_pk_bf16_f32 v95, v52, v53
  ds_write_b128 v21, v[92:95] offset:0
  v_lshlrev_b32 v50, 16, v84
  v_and_b32 v51, 0xffff0000, v84
  buffer_load_dwordx4 v6, s[8:11], s42 offen offset:0 lds
  v_pk_fma_f32 v[50:51], v[50:51], v[44:45], v[46:47] op_sel_hi:[1,0,0]
  v_cvt_pk_bf16_f32 v96, v50, v51
  v_lshlrev_b32 v52, 16, v85
  v_and_b32 v53, 0xffff0000, v85
  v_pk_fma_f32 v[52:53], v[52:53], v[44:45], v[46:47] op_sel_hi:[1,0,0]
  v_cvt_pk_bf16_f32 v97, v52, v53
  v_lshlrev_b32 v50, 16, v86
  v_and_b32 v51, 0xffff0000, v86
  v_pk_fma_f32 v[50:51], v[50:51], v[44:45], v[46:47] op_sel_hi:[1,0,0]
  v_cvt_pk_bf16_f32 v98, v50, v51
  v_lshlrev_b32 v52, 16, v87
  v_and_b32 v53, 0xffff0000, v87
  v_pk_fma_f32 v[52:53], v[52:53], v[44:45], v[46:47] op_sel_hi:[1,0,0]
  v_cvt_pk_bf16_f32 v99, v52, v53
  ds_write_b128 v21, v[96:99] offset:128
  v_lshlrev_b32 v50, 16, v88
  buffer_load_dwordx4 v7, s[8:11], s42 offen offset:1024 lds
  v_and_b32 v51, 0xffff0000, v88
  v_pk_fma_f32 v[50:51], v[50:51], v[44:45], v[46:47] op_sel_hi:[1,0,0]
  v_cvt_pk_bf16_f32 v100, v50, v51
  v_lshlrev_b32 v52, 16, v89
  v_and_b32 v53, 0xffff0000, v89
  v_pk_fma_f32 v[52:53], v[52:53], v[44:45], v[46:47] op_sel_hi:[1,0,0]
  v_cvt_pk_bf16_f32 v101, v52, v53
  v_lshlrev_b32 v50, 16, v90
  v_and_b32 v51, 0xffff0000, v90
  v_pk_fma_f32 v[50:51], v[50:51], v[44:45], v[46:47] op_sel_hi:[1,0,0]
  v_cvt_pk_bf16_f32 v102, v50, v51
  v_lshlrev_b32 v52, 16, v91
  v_and_b32 v53, 0xffff0000, v91
  v_pk_fma_f32 v[52:53], v[52:53], v[44:45], v[46:47] op_sel_hi:[1,0,0]
  v_cvt_pk_bf16_f32 v103, v52, v53
  ds_write_b128 v21, v[100:103] offset:256
  s_waitcnt vmcnt(10)
  s_waitcnt lgkmcnt(0)
  s_barrier
  ds_read_b128 a[0:3], v22 offset:0
  ds_read_b128 a[4:7], v22 offset:6144
  buffer_load_dwordx4 v8, s[8:11], s42 offen offset:2048 lds
  s_add_u32 m0, s32, 61440
  s_add_u32 s42, s30, 182272
  ds_read_b64_tr_b16 v[200:201], v12 offset:0
  ds_read_b64_tr_b16 v[202:203], v12 offset:512
  ds_read_b64_tr_b16 v[204:205], v13 offset:0
  ds_read_b64_tr_b16 v[206:207], v13 offset:512
  ds_read_b64_tr_b16 v[208:209], v14 offset:0
  buffer_load_dwordx4 v6, s[8:11], s42 offen offset:0 lds
  ds_read_b64_tr_b16 v[210:211], v14 offset:512
  ds_read_b128 a[8:11], v23 offset:0
  ds_read_b128 a[12:15], v23 offset:6144
  ds_read_b64_tr_b16 v[212:213], v12 offset:12288
  ds_read_b64_tr_b16 v[214:215], v12 offset:12800
  buffer_load_dwordx4 v7, s[8:11], s42 offen offset:1024 lds
  ds_read_b64_tr_b16 v[216:217], v13 offset:12288
  ds_read_b64_tr_b16 v[218:219], v13 offset:12800
  ds_read_b64_tr_b16 v[220:221], v14 offset:12288
  ds_read_b64_tr_b16 v[222:223], v14 offset:12800
  buffer_load_dwordx4 v8, s[8:11], s42 offen offset:2048 lds
  s_add_u32 m0, s32, 73728
  s_add_u32 s42, s30, 384
  ds_read_b128 a[16:19], v22 offset:128
  ds_read_b128 a[20:23], v22 offset:6272
  ds_read_b128 a[24:27], v23 offset:128
  ds_read_b128 a[28:31], v23 offset:6272
  ds_read_b128 a[32:35], v22 offset:256
  buffer_load_dwordx4 v4, s[8:11], s42 offen offset:0 lds
  s_add_u32 m0, m0, 896
  ds_read_b128 a[36:39], v22 offset:6400
  ds_read_b128 a[40:43], v23 offset:256
  ds_read_b128 a[44:47], v23 offset:6400
  ds_read_b64 v[92:93], v24 offset:16384
  ds_read_b64 v[96:97], v25 offset:16384
  buffer_load_dwordx4 v4, s[8:11], s42 offen offset:128 lds
  s_add_u32 m0, m0, 896
  ds_read_b64 v[100:101], v26 offset:16384
  ds_read_b64 v[94:95], v24 offset:22528
  s_bitcmp1_b32 s99, 0
  s_cbranch_scc0 standalone__video_timesformer__vision_kernel_ml0
  buffer_load_dwordx4 a[48:51], v41, s[16:19], s38 offen offset:0
  buffer_load_dwordx4 a[72:75], v41, s[16:19], s39 offen offset:0
  buffer_load_dwordx4 a[52:55], v41, s[16:19], s38 offen offset:64
  buffer_load_dwordx4 a[76:79], v41, s[16:19], s39 offen offset:64
  buffer_load_dwordx4 a[56:59], v41, s[16:19], s38 offen offset:128
  buffer_load_dwordx4 a[80:83], v41, s[16:19], s39 offen offset:128
standalone__video_timesformer__vision_kernel_ml0:
  ds_read_b64 v[98:99], v25 offset:22528
  ds_read_b64 v[102:103], v26 offset:22528
  s_mul_i32 s98, s98, 0x9e3779b1
  s_add_u32 s98, s98, 0x7f4a7c15
  v_mov_b32 v38, s98
  s_bitcmp1_b32 s99, 0
  s_cbranch_scc1 WR_3
  s_waitcnt vmcnt(8)
WR_3:
  s_waitcnt vmcnt(14)
  s_waitcnt lgkmcnt(0)
  s_barrier
  ds_read_b64_tr_b16 v[224:225], v12 offset:24576
  buffer_load_dwordx4 v4, s[8:11], s42 offen offset:256 lds
  s_add_u32 m0, s32, 86016
  s_add_u32 s42, s30, 35200
  v_mfma_f32_16x16x32_bf16 v[104:107], v[200:203], a[0:3], 0
  ds_read_b64_tr_b16 v[226:227], v12 offset:25088
  ds_read_b64_tr_b16 v[228:229], v13 offset:24576
  v_lshlrev_b32 v176, 16, v92
  v_mfma_f32_16x16x32_bf16 v[108:111], v[200:203], a[4:7], 0
  v_and_b32 v177, 0xffff0000, v92
  ds_read_b64_tr_b16 v[230:231], v13 offset:25088
  buffer_load_dwordx4 v6, s[8:11], s42 offen offset:0 lds
  v_lshlrev_b32 v178, 16, v93
  v_mfma_f32_16x16x32_bf16 v[112:115], v[204:207], a[0:3], 0
  ds_read_b64_tr_b16 v[232:233], v14 offset:24576
  v_and_b32 v179, 0xffff0000, v93
  ds_read_b64_tr_b16 v[234:235], v14 offset:25088
  v_lshlrev_b32 v180, 16, v94
  v_mfma_f32_16x16x32_bf16 v[116:119], v[204:207], a[4:7], 0
  v_and_b32 v181, 0xffff0000, v94
  ds_read_b64_tr_b16 v[236:237], v12 offset:36864
  v_lshlrev_b32 v182, 16, v95
  buffer_load_dwordx4 v7, s[8:11], s42 offen offset:1024 lds
  v_mfma_f32_16x16x32_bf16 v[120:123], v[208:211], a[0:3], 0
  ds_read_b64_tr_b16 v[238:239], v12 offset:37376
  v_and_b32 v183, 0xffff0000, v95
  ds_read_b64_tr_b16 v[240:241], v13 offset:36864
  v_lshlrev_b32 v184, 16, v96
  v_mfma_f32_16x16x32_bf16 v[124:127], v[208:211], a[4:7], 0
  v_and_b32 v185, 0xffff0000, v96
  ds_read_b64_tr_b16 v[242:243], v13 offset:37376
  v_lshlrev_b32 v186, 16, v97
  ds_read_b64_tr_b16 v[244:245], v14 offset:36864
  buffer_load_dwordx4 v8, s[8:11], s42 offen offset:2048 lds
  s_add_u32 m0, s32, 98304
  s_add_u32 s42, s30, 72064
  v_mfma_f32_16x16x32_bf16 v[104:107], v[212:215], a[8:11], v[104:107]
  v_and_b32 v187, 0xffff0000, v97
  ds_read_b64_tr_b16 v[246:247], v14 offset:37376
  v_lshlrev_b32 v188, 16, v98
  v_and_b32 v189, 0xffff0000, v98
  v_mfma_f32_16x16x32_bf16 v[108:111], v[212:215], a[12:15], v[108:111]
  v_lshlrev_b32 v190, 16, v99
  v_and_b32 v191, 0xffff0000, v99
  buffer_load_dwordx4 v6, s[8:11], s42 offen offset:0 lds
  v_mfma_f32_16x16x32_bf16 v[112:115], v[216:219], a[8:11], v[112:115]
  v_lshlrev_b32 v192, 16, v100
  v_and_b32 v193, 0xffff0000, v100
  v_mfma_f32_16x16x32_bf16 v[116:119], v[216:219], a[12:15], v[116:119]
  v_lshlrev_b32 v194, 16, v101
  v_and_b32 v195, 0xffff0000, v101
  buffer_load_dwordx4 v7, s[8:11], s42 offen offset:1024 lds
  v_mfma_f32_16x16x32_bf16 v[120:123], v[220:223], a[8:11], v[120:123]
  v_lshlrev_b32 v196, 16, v102
  v_and_b32 v197, 0xffff0000, v102
  s_bitcmp1_b32 s99, 0
  s_cbranch_scc0 standalone__video_timesformer__vision_kernel_ml1
  buffer_load_dwordx4 a[60:63], v41, s[16:19], s38 offen offset:192
  buffer_load_dwordx4 a[84:87], v41, s[16:19], s39 offen offset:192
  buffer_load_dwordx4 a[64:67], v41, s[16:19], s38 offen offset:256
  buffer_load_dwordx4 a[88:91], v41, s[16:19], s39 offen offset:256
  buffer_load_dwordx4 a[68:71], v41, s[16:19], s38 offen offset:320
  buffer_load_dwordx4 a[92:95], v41, s[16:19], s39 offen offset:320
standalone__video_timesformer__vision_kernel_ml1:
  v_mfma_f32_16x16x32_bf16 v[124:127], v[220:223], a[12:15], v[124:127]
  v_lshlrev_b32 v198, 16, v103
  v_and_b32 v199, 0xffff0000, v103
  s_bitcmp1_b32 s99, 0
  s_cbranch_scc1 WR_4
  s_waitcnt vmcnt(8)
WR_4:
  s_waitcnt vmcnt(20)
  s_waitcnt lgkmcnt(0)
  s_barrier
  ds_read_b64_tr_b16 v[200:201], v15 offset:0
  buffer_load_dwordx4 v8, s[8:11], s42 offen offset:2048 lds
  s_add_u32 m0, s32, 110592
  s_add_u32 s42, s30, 108928
  v_mfma_f32_16x16x32_bf16 v[104:107], v[224:227], a[16:19], v[104:107]
  ds_read_b64_tr_b16 v[202:203], v15 offset:512
  ds_read_b64_tr_b16 v[204:205], v16 offset:0
  v_mfma_f32_16x16x32_bf16 v[108:111], v[224:227], a[20:23], v[108:111]
  ds_read_b64_tr_b16 v[206:207], v16 offset:512
  buffer_load_dwordx4 v6, s[8:11], s42 offen offset:0 lds
  v_mfma_f32_16x16x32_bf16 v[112:115], v[228:231], a[16:19], v[112:115]
  ds_read_b64_tr_b16 v[208:209], v17 offset:0
  ds_read_b64_tr_b16 v[210:211], v17 offset:512
  v_mfma_f32_16x16x32_bf16 v[116:119], v[228:231], a[20:23], v[116:119]
  ds_read_b64_tr_b16 v[212:213], v15 offset:12288
  buffer_load_dwordx4 v7, s[8:11], s42 offen offset:1024 lds
  v_mfma_f32_16x16x32_bf16 v[120:123], v[232:235], a[16:19], v[120:123]
  ds_read_b64_tr_b16 v[214:215], v15 offset:12800
  ds_read_b64_tr_b16 v[216:217], v16 offset:12288
  v_mfma_f32_16x16x32_bf16 v[124:127], v[232:235], a[20:23], v[124:127]
  ds_read_b64_tr_b16 v[218:219], v16 offset:12800
  ds_read_b64_tr_b16 v[220:221], v17 offset:12288
  buffer_load_dwordx4 v8, s[8:11], s42 offen offset:2048 lds
  s_add_u32 m0, s32, 122880
  s_add_u32 s42, s30, 145792
  v_mfma_f32_16x16x32_bf16 v[104:107], v[236:239], a[24:27], v[104:107]
  ds_read_b64_tr_b16 v[222:223], v17 offset:12800
  v_mfma_f32_16x16x32_bf16 v[108:111], v[236:239], a[28:31], v[108:111]
  buffer_load_dwordx4 v6, s[8:11], s42 offen offset:0 lds
  v_mfma_f32_16x16x32_bf16 v[112:115], v[240:243], a[24:27], v[112:115]
  v_mfma_f32_16x16x32_bf16 v[116:119], v[240:243], a[28:31], v[116:119]
  buffer_load_dwordx4 v7, s[8:11], s42 offen offset:1024 lds
  v_mfma_f32_16x16x32_bf16 v[120:123], v[244:247], a[24:27], v[120:123]
  v_mfma_f32_16x16x32_bf16 v[124:127], v[244:247], a[28:31], v[124:127]
  s_bitcmp1_b32 s99, 0
  s_cbranch_scc1 WR_5
  s_waitcnt vmcnt(8)
WR_5:
  s_waitcnt vmcnt(14)
  s_waitcnt lgkmcnt(0)
  s_barrier
  s_bitcmp1_b32 s99, 0
  s_cbranch_scc0 standalone__video_timesformer__vision_kernel_mw
  s_waitcnt vmcnt(6)
standalone__video_timesformer__vision_kernel_mw:
  ds_read_b64_tr_b16 v[224:225], v15 offset:24576
  buffer_load_dwordx4 v8, s[8:11], s42 offen offset:2048 lds
  s_add_u32 m0, s32, 0
  s_add_u32 s42, s30, 182656
  v_mfma_f32_16x16x32_bf16 v[104:107], v[200:203], a[32:35], v[104:107]
  ds_read_b64_tr_b16 v[226:227], v15 offset:25088
  v_mfma_f32_16x16x32_bf16 v[72:75], a[48:51], a[72:75], 0
  ds_read_b64_tr_b16 v[228:229], v16 offset:24576
  v_mfma_f32_16x16x32_bf16 v[108:111], v[200:203], a[36:39], v[108:111]
  ds_read_b64_tr_b16 v[230:231], v16 offset:25088
  buffer_load_dwordx4 v6, s[8:11], s42 offen offset:0 lds
  v_mfma_f32_16x16x32_bf16 v[112:115], v[204:207], a[32:35], v[112:115]
  v_mfma_f32_16x16x32_bf16 v[72:75], a[52:55], a[76:79], v[72:75]
  ds_read_b64_tr_b16 v[232:233], v17 offset:24576
  ds_read_b64_tr_b16 v[234:235], v17 offset:25088
  v_mfma_f32_16x16x32_bf16 v[116:119], v[204:207], a[36:39], v[116:119]
  ds_read_b64_tr_b16 v[236:237], v15 offset:36864
  buffer_load_dwordx4 v7, s[8:11], s42 offen offset:1024 lds
  v_mfma_f32_16x16x32_bf16 v[72:75], a[56:59], a[80:83], v[72:75]
  v_mfma_f32_16x16x32_bf16 v[120:123], v[208:211], a[32:35], v[120:123]
  ds_read_b64_tr_b16 v[238:239], v15 offset:37376
  ds_read_b64_tr_b16 v[240:241], v16 offset:36864
  v_mfma_f32_16x16x32_bf16 v[124:127], v[208:211], a[36:39], v[124:127]
  ds_read_b64_tr_b16 v[242:243], v16 offset:37376
  v_mfma_f32_16x16x32_bf16 v[72:75], a[60:63], a[84:87], v[72:75]
  ds_read_b64_tr_b16 v[244:245], v17 offset:36864
  buffer_load_dwordx4 v8, s[8:11], s42 offen offset:2048 lds
  s_add_u32 m0, s32, 12288
  s_add_u32 s42, s30, 768
  v_mfma_f32_16x16x32_bf16 v[104:107], v[212:215], a[40:43], v[104:107]
  ds_read_b64_tr_b16 v[246:247], v17 offset:37376
  v_mfma_f32_16x16x32_bf16 v[108:111], v[212:215], a[44:47], v[108:111]
  v_mfma_f32_16x16x32_bf16 v[72:75], a[64:67], a[88:91], v[72:75]
  buffer_load_dwordx4 v4, s[8:11], s42 offen offset:0 lds
  s_add_u32 m0, m0, 896
  v_mfma_f32_16x16x32_bf16 v[112:115], v[216:219], a[40:43], v[112:115]
  v_mfma_f32_16x16x32_bf16 v[116:119], v[216:219], a[44:47], v[116:119]
  v_mfma_f32_16x16x32_bf16 v[72:75], a[68:71], a[92:95], v[72:75]
  buffer_load_dwordx4 v4, s[8:11], s42 offen offset:128 lds
  s_add_u32 m0, m0, 896
  v_mfma_f32_16x16x32_bf16 v[120:123], v[220:223], a[40:43], v[120:123]
  v_mfma_f32_16x16x32_bf16 v[124:127], v[220:223], a[44:47], v[124:127]
  s_nop 3
  v_mul_f32 v72, 0x3dd53b95, v72
  v_mul_f32 v73, 0x3dd53b95, v73
  v_mul_f32 v74, 0x3dd53b95, v74
  v_mul_f32 v75, 0x3dd53b95, v75
  v_cvt_pk_bf16_f32 v76, v72, v73
  v_cvt_pk_bf16_f32 v77, v74, v75
  s_bitcmp1_b32 s99, 0
  s_cbranch_scc0 standalone__video_timesformer__vision_kernel_ms
  s_mov_b64 exec, 0x3
  buffer_store_dword v68, v66, s[4:7], 0 offen sc1
  s_mov_b64 exec, -1
  buffer_store_dwordx2 v[76:77], v67, s[4:7], s40 offen sc1
standalone__video_timesformer__vision_kernel_ms:
  s_bitcmp1_b32 s99, 0
  s_cbranch_scc1 WR_6
  s_waitcnt vmcnt(8)
WR_6:
  s_waitcnt vmcnt(10)
  s_waitcnt lgkmcnt(0)
  s_barrier
  ds_read_b64_tr_b16 v[200:201], v18 offset:0
  buffer_load_dwordx4 v4, s[8:11], s42 offen offset:256 lds
  s_add_u32 m0, s32, 24576
  s_add_u32 s42, s30, 35584
  v_mfma_f32_16x16x32_bf16 v[128:131], v[224:227], a[0:3], 0
  ds_read_b64_tr_b16 v[202:203], v18 offset:512
  ds_read_b64_tr_b16 v[204:205], v19 offset:0
  v_cvt_pk_bf16_f32 v80, v104, v105
  v_mfma_f32_16x16x32_bf16 v[132:135], v[224:227], a[4:7], 0
  ds_read_b64_tr_b16 v[206:207], v19 offset:512
  buffer_load_dwordx4 v6, s[8:11], s42 offen offset:0 lds
  v_cvt_pk_bf16_f32 v81, v106, v107
  v_mfma_f32_16x16x32_bf16 v[136:139], v[228:231], a[0:3], 0
  ds_read_b64_tr_b16 v[208:209], v20 offset:0
  ds_read_b64_tr_b16 v[210:211], v20 offset:512
  v_cvt_pk_bf16_f32 v82, v108, v109
  v_mfma_f32_16x16x32_bf16 v[140:143], v[228:231], a[4:7], 0
  ds_read_b64_tr_b16 v[212:213], v18 offset:12288
  v_cvt_pk_bf16_f32 v83, v110, v111
  buffer_load_dwordx4 v7, s[8:11], s42 offen offset:1024 lds
  v_mfma_f32_16x16x32_bf16 v[144:147], v[232:235], a[0:3], 0
  ds_read_b64_tr_b16 v[214:215], v18 offset:12800
  ds_read_b64_tr_b16 v[216:217], v19 offset:12288
  v_cvt_pk_bf16_f32 v84, v112, v113
  v_mfma_f32_16x16x32_bf16 v[148:151], v[232:235], a[4:7], 0
  ds_read_b64_tr_b16 v[218:219], v19 offset:12800
  v_cvt_pk_bf16_f32 v85, v114, v115
  ds_read_b64_tr_b16 v[220:221], v20 offset:12288
  buffer_load_dwordx4 v8, s[8:11], s42 offen offset:2048 lds
  s_add_u32 m0, s32, 36864
  s_add_u32 s42, s30, 72448
  v_mfma_f32_16x16x32_bf16 v[128:131], v[236:239], a[8:11], v[128:131]
  ds_read_b64_tr_b16 v[222:223], v20 offset:12800
  v_cvt_pk_bf16_f32 v86, v116, v117
  v_mfma_f32_16x16x32_bf16 v[132:135], v[236:239], a[12:15], v[132:135]
  v_cvt_pk_bf16_f32 v87, v118, v119
  buffer_load_dwordx4 v6, s[8:11], s42 offen offset:0 lds
  v_mfma_f32_16x16x32_bf16 v[136:139], v[240:243], a[8:11], v[136:139]
  v_cvt_pk_bf16_f32 v88, v120, v121
  v_mfma_f32_16x16x32_bf16 v[140:143], v[240:243], a[12:15], v[140:143]
  v_cvt_pk_bf16_f32 v89, v122, v123
  buffer_load_dwordx4 v7, s[8:11], s42 offen offset:1024 lds
  v_mfma_f32_16x16x32_bf16 v[144:147], v[244:247], a[8:11], v[144:147]
  v_cvt_pk_bf16_f32 v90, v124, v125
  v_mfma_f32_16x16x32_bf16 v[148:151], v[244:247], a[12:15], v[148:151]
  v_cvt_pk_bf16_f32 v91, v126, v127
  s_bitcmp1_b32 s99, 0
  s_cbranch_scc1 WR_7
  s_waitcnt vmcnt(11)
WR_7:
  s_waitcnt vmcnt(13)
  s_waitcnt lgkmcnt(0)
  s_barrier
  ds_read_b64_tr_b16 v[224:225], v18 offset:24576
  buffer_load_dwordx4 v8, s[8:11], s42 offen offset:2048 lds
  s_add_u32 m0, s32, 49152
  s_add_u32 s42, s30, 109312
  v_mfma_f32_16x16x32_bf16 v[128:131], v[200:203], a[16:19], v[128:131]
  ds_read_b64_tr_b16 v[226:227], v18 offset:25088
  v_mfma_f32_16x16x32_bf16 v[132:135], v[200:203], a[20:23], v[132:135]
  ds_read_b64_tr_b16 v[228:229], v19 offset:24576
  v_mfma_f32_16x16x32_bf16 v[136:139], v[204:207], a[16:19], v[136:139]
  ds_read_b64_tr_b16 v[230:231], v19 offset:25088
  v_mfma_f32_16x16x32_bf16 v[140:143], v[204:207], a[20:23], v[140:143]
  ds_read_b64_tr_b16 v[232:233], v20 offset:24576
  ds_read_b64_tr_b16 v[234:235], v20 offset:25088
  buffer_load_dwordx4 v6, s[8:11], s42 offen offset:0 lds
  v_mfma_f32_16x16x32_bf16 v[144:147], v[208:211], a[16:19], v[144:147]
  v_mfma_f32_16x16x32_bf16 v[148:151], v[208:211], a[20:23], v[148:151]
  v_mfma_f32_16x16x32_bf16 v[128:131], v[212:215], a[24:27], v[128:131]
  v_mfma_f32_16x16x32_bf16 v[132:135], v[212:215], a[28:31], v[132:135]
  buffer_load_dwordx4 v7, s[8:11], s42 offen offset:1024 lds
  v_mfma_f32_16x16x32_bf16 v[136:139], v[216:219], a[24:27], v[136:139]
  v_mfma_f32_16x16x32_bf16 v[140:143], v[216:219], a[28:31], v[140:143]
  v_mfma_f32_16x16x32_bf16 v[144:147], v[220:223], a[24:27], v[144:147]
  v_mfma_f32_16x16x32_bf16 v[148:151], v[220:223], a[28:31], v[148:151]
  s_bitcmp1_b32 s99, 0
  s_cbranch_scc1 WR_8
  s_waitcnt vmcnt(11)
WR_8:
  s_waitcnt vmcnt(13)
  s_waitcnt lgkmcnt(0)
  s_barrier
  s_bitcmp1_b32 s99, 0
  s_cbranch_scc0 standalone__video_timesformer__vision_kernel_fp
  s_waitcnt vmcnt(9)
  s_mov_b64 exec, 1
  buffer_store_dword v38, off, s[4:7], s41 sc1
  s_mov_b64 exec, -1
standalone__video_timesformer__vision_kernel_fp:
  ds_read_b64_tr_b16 v[236:237], v12 offset:0
  ds_read_b64_tr_b16 v[238:239], v12 offset:512
  ds_read_b64_tr_b16 v[240:241], v13 offset:0
  ds_read_b64_tr_b16 v[242:243], v13 offset:512
  ds_read_b64_tr_b16 v[244:245], v14 offset:0
  ds_read_b64_tr_b16 v[246:247], v14 offset:512
  v_mfma_f32_16x16x32_bf16 v[128:131], v[224:227], a[32:35], v[128:131]
  buffer_load_dwordx4 v8, s[8:11], s42 offen offset:2048 lds
  s_add_u32 m0, s32, 61440
  s_add_u32 s42, s30, 146176
  v_mfma_f32_16x16x32_bf16 v[132:135], v[224:227], a[36:39], v[132:135]
  v_mfma_f32_16x16x32_bf16 v[136:139], v[228:231], a[32:35], v[136:139]
  v_mfma_f32_16x16x32_bf16 v[140:143], v[228:231], a[36:39], v[140:143]
  buffer_load_dwordx4 v6, s[8:11], s42 offen offset:0 lds
  v_mfma_f32_16x16x32_bf16 v[144:147], v[232:235], a[32:35], v[144:147]
  v_mfma_f32_16x16x32_bf16 v[148:151], v[232:235], a[36:39], v[148:151]
  s_waitcnt lgkmcnt(4)
  v_mfma_f32_16x16x32_bf16 v[128:131], v[236:239], a[40:43], v[128:131]
  v_mfma_f32_16x16x32_bf16 v[132:135], v[236:239], a[44:47], v[132:135]
  buffer_load_dwordx4 v7, s[8:11], s42 offen offset:1024 lds
  s_waitcnt lgkmcnt(2)
  v_mfma_f32_16x16x32_bf16 v[136:139], v[240:243], a[40:43], v[136:139]
  v_mfma_f32_16x16x32_bf16 v[140:143], v[240:243], a[44:47], v[140:143]
  s_waitcnt lgkmcnt(0)
  v_mfma_f32_16x16x32_bf16 v[144:147], v[244:247], a[40:43], v[144:147]
  v_mfma_f32_16x16x32_bf16 v[148:151], v[244:247], a[44:47], v[148:151]
  buffer_load_dwordx4 v8, s[8:11], s42 offen offset:2048 lds
  s_add_u32 m0, s32, 73728
  s_add_u32 s42, s30, 183040
  v_cvt_pk_bf16_f32 v92, v128, v129
  v_cvt_pk_bf16_f32 v93, v130, v131
  v_cvt_pk_bf16_f32 v94, v132, v133
  v_cvt_pk_bf16_f32 v95, v134, v135
  v_cvt_pk_bf16_f32 v96, v136, v137
  buffer_load_dwordx4 v6, s[8:11], s42 offen offset:0 lds
  v_cvt_pk_bf16_f32 v97, v138, v139
  v_cvt_pk_bf16_f32 v98, v140, v141
  v_cvt_pk_bf16_f32 v99, v142, v143
  v_mfma_f32_16x16x16_bf16 v[48:51], v[92:93], v[80:81], 0
  buffer_load_dwordx4 v7, s[8:11], s42 offen offset:1024 lds
  v_mfma_f32_16x16x16_bf16 v[52:55], v[94:95], v[82:83], 0
  v_cvt_pk_bf16_f32 v100, v144, v145
  v_cvt_pk_bf16_f32 v101, v146, v147
  v_cvt_pk_bf16_f32 v102, v148, v149
  v_cvt_pk_bf16_f32 v103, v150, v151
  buffer_load_dwordx4 v8, s[8:11], s42 offen offset:2048 lds
  s_add_u32 m0, s32, 86016
  s_add_u32 s42, s31, 0
  v_mfma_f32_16x16x16_bf16 v[48:51], v[96:97], v[84:85], v[48:51]
  v_mfma_f32_16x16x16_bf16 v[52:55], v[98:99], v[86:87], v[52:55]
  v_mfma_f32_16x16x16_bf16 v[48:51], v[100:101], v[88:89], v[48:51]
  v_mfma_f32_16x16x16_bf16 v[52:55], v[102:103], v[90:91], v[52:55]
  s_nop 6
  ds_write_b128 v28, v[48:51] offset:0
  ds_write_b128 v28, v[52:55] offset:1024
  buffer_load_dwordx4 v5, s[12:15], s42 offen offset:0 lds
  s_add_u32 m0, m0, 896
  s_bitcmp1_b32 s99, 0
  s_cbranch_scc1 WR_9
  s_waitcnt vmcnt(13)
WR_9:
  s_waitcnt vmcnt(14)
  s_waitcnt lgkmcnt(0)
  s_barrier
  ds_read_b128 v[104:107], v27 offset:0
  ds_read_b128 v[112:115], v27 offset:2048
  ds_read_b128 v[120:123], v27 offset:4096
  ds_read_b128 v[128:131], v27 offset:6144
  ds_read_b128 v[108:111], v27 offset:1024
  ds_read_b128 v[116:119], v27 offset:3072
  ds_read_b128 v[124:127], v27 offset:5120
  ds_read_b128 v[132:135], v27 offset:7168
  ds_read_b64_tr_b16 v[200:201], v12 offset:12288
  ds_read_b64_tr_b16 v[202:203], v12 offset:12800
  buffer_load_dwordx4 v5, s[12:15], s42 offen offset:128 lds
  s_add_u32 m0, m0, 896
  ds_read_b64_tr_b16 v[204:205], v13 offset:12288
  ds_read_b64_tr_b16 v[206:207], v13 offset:12800
  ds_read_b64_tr_b16 v[208:209], v14 offset:12288
  ds_read_b64_tr_b16 v[210:211], v14 offset:12800
  ds_read_b64_tr_b16 v[212:213], v12 offset:24576
  buffer_load_dwordx4 v5, s[12:15], s42 offen offset:256 lds
  s_add_u32 m0, s32, 98304
  s_add_u32 s42, s31, 10240
  ds_read_b64_tr_b16 v[214:215], v12 offset:25088
  ds_read_b64_tr_b16 v[216:217], v13 offset:24576
  ds_read_b64_tr_b16 v[218:219], v13 offset:25088
  ds_read_b64_tr_b16 v[220:221], v14 offset:24576
  ds_read_b64_tr_b16 v[222:223], v14 offset:25088
  s_waitcnt lgkmcnt(15)
  v_add_f32 v104, v104, v112
  s_waitcnt lgkmcnt(14)
  v_add_f32 v108, v108, v116
  v_add_f32 v120, v120, v128
  s_waitcnt lgkmcnt(12)
  v_add_f32 v124, v124, v132
  v_add_f32 v105, v105, v113
  buffer_load_dwordx4 v9, s[12:15], s42 offen offset:0 lds
  v_add_f32 v109, v109, v117
  v_add_f32 v121, v121, v129
  v_add_f32 v125, v125, v133
  v_add_f32 v106, v106, v114
  v_add_f32 v110, v110, v118
  v_add_f32 v122, v122, v130
  v_add_f32 v126, v126, v134
  buffer_load_dwordx4 v10, s[12:15], s42 offen offset:1024 lds
  v_add_f32 v107, v107, v115
  s_waitcnt lgkmcnt(10)
  v_mfma_f32_16x16x32_bf16 v[152:155], a[0:3], v[200:203], 0
  v_add_f32 v111, v111, v119
  v_add_f32 v123, v123, v131
  v_mfma_f32_16x16x32_bf16 v[156:159], a[4:7], v[200:203], 0
  v_add_f32 v127, v127, v135
  v_add_f32 v104, v104, v120
  s_waitcnt lgkmcnt(8)
  v_mfma_f32_16x16x32_bf16 v[160:163], a[0:3], v[204:207], 0
  v_add_f32 v108, v108, v124
  v_add_f32 v105, v105, v121
  buffer_load_dwordx4 v11, s[12:15], s42 offen offset:2048 lds
  s_add_u32 m0, s32, 110592
  s_add_u32 s42, s31, 22528
  v_add_f32 v109, v109, v125
  v_mfma_f32_16x16x32_bf16 v[164:167], a[4:7], v[204:207], 0
  v_add_f32 v106, v106, v122
  v_add_f32 v110, v110, v126
  s_waitcnt lgkmcnt(6)
  v_mfma_f32_16x16x32_bf16 v[168:171], a[0:3], v[208:211], 0
  v_add_f32 v107, v107, v123
  v_add_f32 v111, v111, v127
  v_mfma_f32_16x16x32_bf16 v[172:175], a[4:7], v[208:211], 0
  v_max_f32 v140, v104, v105
  v_max_f32 v144, v108, v109
  buffer_load_dwordx4 v9, s[12:15], s42 offen offset:0 lds
  s_waitcnt lgkmcnt(4)
  v_mfma_f32_16x16x32_bf16 v[152:155], a[8:11], v[212:215], v[152:155]
  v_max3_f32 v140, v106, v107, v140
  v_max3_f32 v144, v110, v111, v144
  v_mov_b32 v141, v140
  v_mfma_f32_16x16x32_bf16 v[156:159], a[12:15], v[212:215], v[156:159]
  v_mov_b32 v145, v144
  v_permlane16_swap_b32 v140, v141
  s_waitcnt lgkmcnt(2)
  v_mfma_f32_16x16x32_bf16 v[160:163], a[8:11], v[216:219], v[160:163]
  v_permlane16_swap_b32 v144, v145
  v_max_f32 v140, v140, v141
  buffer_load_dwordx4 v10, s[12:15], s42 offen offset:1024 lds
  v_max_f32 v144, v144, v145
  v_mfma_f32_16x16x32_bf16 v[164:167], a[12:15], v[216:219], v[164:167]
  v_mul_f32 v140, 0xbdd53b95, v140
  v_mul_f32 v144, 0xbdd53b95, v144
  s_waitcnt lgkmcnt(0)
  v_mfma_f32_16x16x32_bf16 v[168:171], a[8:11], v[220:223], v[168:171]
  v_mov_b32 v141, 0x3dd53b95
  v_mov_b32 v145, 0x3dd53b95
  v_mfma_f32_16x16x32_bf16 v[172:175], a[12:15], v[220:223], v[172:175]
  v_fma_f32 v104, v104, v141, v140
  v_fma_f32 v108, v108, v145, v144
  s_waitcnt vmcnt(14)
  s_waitcnt lgkmcnt(0)
  s_barrier
  ds_read_b64_tr_b16 v[224:225], v12 offset:36864
  v_fma_f32 v105, v105, v141, v140
  v_fma_f32 v109, v109, v145, v144
  ds_read_b64_tr_b16 v[226:227], v12 offset:37376
  v_fma_f32 v106, v106, v141, v140
  buffer_load_dwordx4 v11, s[12:15], s42 offen offset:2048 lds
  s_add_u32 m0, s32, 122880
  s_add_u32 s42, s31, 34816
  ds_read_b64_tr_b16 v[228:229], v13 offset:36864
  v_fma_f32 v110, v110, v145, v144
  v_fma_f32 v107, v107, v141, v140
  ds_read_b64_tr_b16 v[230:231], v13 offset:37376
  v_fma_f32 v111, v111, v145, v144
  ds_read_b64_tr_b16 v[232:233], v14 offset:36864
  v_exp_f32 v104, v104
  ds_read_b64_tr_b16 v[234:235], v14 offset:37376
  v_exp_f32 v108, v108
  v_exp_f32 v105, v105
  ds_read_b64_tr_b16 v[236:237], v15 offset:0
  buffer_load_dwordx4 v9, s[12:15], s42 offen offset:0 lds
  v_exp_f32 v109, v109
  ds_read_b64_tr_b16 v[238:239], v15 offset:512
  v_exp_f32 v106, v106
  v_exp_f32 v110, v110
  ds_read_b64_tr_b16 v[240:241], v16 offset:0
  v_exp_f32 v107, v107
  ds_read_b64_tr_b16 v[242:243], v16 offset:512
  v_exp_f32 v111, v111
  ds_read_b64_tr_b16 v[244:245], v17 offset:0
  v_add_f32 v142, v104, v105
  v_add_f32 v146, v108, v109
  buffer_load_dwordx4 v10, s[12:15], s42 offen offset:1024 lds
  ds_read_b64_tr_b16 v[246:247], v17 offset:512
  v_add_f32 v143, v106, v107
  s_waitcnt lgkmcnt(10)
  v_mfma_f32_16x16x32_bf16 v[152:155], a[16:19], v[224:227], v[152:155]
  v_add_f32 v147, v110, v111
  v_add_f32 v142, v142, v143
  v_mfma_f32_16x16x32_bf16 v[156:159], a[20:23], v[224:227], v[156:159]
  v_add_f32 v146, v146, v147
  v_mov_b32 v143, v142
  v_mov_b32 v147, v146
  s_waitcnt lgkmcnt(8)
  v_mfma_f32_16x16x32_bf16 v[160:163], a[16:19], v[228:231], v[160:163]
  v_permlane16_swap_b32 v142, v143
  buffer_load_dwordx4 v11, s[12:15], s42 offen offset:2048 lds
  s_add_u32 m0, s32, 0
  s_add_u32 s42, s31, 47104
  v_permlane16_swap_b32 v146, v147
  v_mfma_f32_16x16x32_bf16 v[164:167], a[20:23], v[228:231], v[164:167]
  v_add_f32 v142, v142, v143
  v_add_f32 v146, v146, v147
  s_waitcnt lgkmcnt(6)
  v_mfma_f32_16x16x32_bf16 v[168:171], a[16:19], v[232:235], v[168:171]
  v_rcp_f32 v142, v142
  v_rcp_f32 v146, v146
  v_mfma_f32_16x16x32_bf16 v[172:175], a[20:23], v[232:235], v[172:175]
  v_cndmask_b32 v142, 0, v142, s[100:101]
  buffer_load_dwordx4 v9, s[12:15], s42 offen offset:0 lds
  v_cndmask_b32 v146, 0, v146, s[100:101]
  s_waitcnt lgkmcnt(4)
  v_mfma_f32_16x16x32_bf16 v[152:155], a[24:27], v[236:239], v[152:155]
  v_mul_f32 v104, v104, v142
  v_mul_f32 v108, v108, v146
  v_mfma_f32_16x16x32_bf16 v[156:159], a[28:31], v[236:239], v[156:159]
  v_mul_f32 v105, v105, v142
  v_mul_f32 v109, v109, v146
  s_waitcnt lgkmcnt(2)
  v_mfma_f32_16x16x32_bf16 v[160:163], a[24:27], v[240:243], v[160:163]
  v_mul_f32 v106, v106, v142
  v_mul_f32 v110, v110, v146
  buffer_load_dwordx4 v10, s[12:15], s42 offen offset:1024 lds
  v_mfma_f32_16x16x32_bf16 v[164:167], a[28:31], v[240:243], v[164:167]
  v_mul_f32 v107, v107, v142
  v_mul_f32 v111, v111, v146
  s_waitcnt lgkmcnt(0)
  v_mfma_f32_16x16x32_bf16 v[168:171], a[24:27], v[244:247], v[168:171]
  v_cvt_pk_bf16_f32 v136, v104, v105
  v_cvt_pk_bf16_f32 v138, v108, v109
  v_mfma_f32_16x16x32_bf16 v[172:175], a[28:31], v[244:247], v[172:175]
  v_cvt_pk_bf16_f32 v137, v106, v107
  v_cvt_pk_bf16_f32 v139, v110, v111
  s_waitcnt vmcnt(17)
  s_waitcnt lgkmcnt(0)
  s_barrier
  ds_read_b64_tr_b16 v[200:201], v15 offset:12288
  ds_read_b64_tr_b16 v[202:203], v15 offset:12800
  ds_read_b64_tr_b16 v[204:205], v16 offset:12288
  ds_read_b64_tr_b16 v[206:207], v16 offset:12800
  ds_read_b64_tr_b16 v[208:209], v17 offset:12288
  ds_read_b64_tr_b16 v[210:211], v17 offset:12800
  buffer_load_dwordx4 v11, s[12:15], s42 offen offset:2048 lds
  s_add_u32 m0, s32, 12288
  s_add_u32 s42, s31, 59392
  buffer_load_dwordx4 v9, s[12:15], s42 offen offset:0 lds
  s_waitcnt vmcnt(16)
  s_waitcnt lgkmcnt(0)
  s_barrier
  ds_read_b64_tr_b16 v[212:213], v15 offset:24576
  ds_read_b64_tr_b16 v[214:215], v15 offset:25088
  ds_read_b64_tr_b16 v[216:217], v16 offset:24576
  ds_read_b64_tr_b16 v[218:219], v16 offset:25088
  ds_read_b64_tr_b16 v[220:221], v17 offset:24576
  ds_read_b64_tr_b16 v[222:223], v17 offset:25088
  buffer_load_dword v37, v40, s[4:7], 0 offen sc1
  v_mfma_f32_16x16x32_bf16 v[152:155], a[32:35], v[200:203], v[152:155]
  buffer_load_dwordx4 v10, s[12:15], s42 offen offset:1024 lds
  v_mfma_f32_16x16x32_bf16 v[156:159], a[36:39], v[200:203], v[156:159]
  v_mfma_f32_16x16x32_bf16 v[160:163], a[32:35], v[204:207], v[160:163]
  v_mfma_f32_16x16x32_bf16 v[164:167], a[36:39], v[204:207], v[164:167]
  buffer_load_dwordx4 v11, s[12:15], s42 offen offset:2048 lds
  v_mfma_f32_16x16x32_bf16 v[168:171], a[32:35], v[208:211], v[168:171]
  v_mfma_f32_16x16x32_bf16 v[172:175], a[36:39], v[208:211], v[172:175]
  s_waitcnt lgkmcnt(4)
  v_mfma_f32_16x16x32_bf16 v[152:155], a[40:43], v[212:215], v[152:155]
  v_mfma_f32_16x16x32_bf16 v[156:159], a[44:47], v[212:215], v[156:159]
  s_waitcnt lgkmcnt(2)
  v_mfma_f32_16x16x32_bf16 v[160:163], a[40:43], v[216:219], v[160:163]
  v_mfma_f32_16x16x32_bf16 v[164:167], a[44:47], v[216:219], v[164:167]
  s_waitcnt lgkmcnt(0)
  v_mfma_f32_16x16x32_bf16 v[168:171], a[40:43], v[220:223], v[168:171]
  v_mfma_f32_16x16x32_bf16 v[172:175], a[44:47], v[220:223], v[172:175]
  s_nop 0
  v_cvt_pk_bf16_f32 v80, v152, v153
  v_cvt_pk_bf16_f32 v81, v154, v155
  v_cvt_pk_bf16_f32 v82, v156, v157
  v_cvt_pk_bf16_f32 v83, v158, v159
  v_cvt_pk_bf16_f32 v84, v160, v161
  v_cvt_pk_bf16_f32 v85, v162, v163
  v_mfma_f32_16x16x16_bf16 v[152:155], v[80:81], v[136:137], 0
  v_cvt_pk_bf16_f32 v86, v164, v165
  v_cvt_pk_bf16_f32 v87, v166, v167
  v_mfma_f32_16x16x16_bf16 v[156:159], v[82:83], v[138:139], 0
  v_cvt_pk_bf16_f32 v88, v168, v169
  v_cvt_pk_bf16_f32 v89, v170, v171
  v_mfma_f32_16x16x16_bf16 v[160:163], v[84:85], v[136:137], 0
  v_cvt_pk_bf16_f32 v90, v172, v173
  v_cvt_pk_bf16_f32 v91, v174, v175
  v_mfma_f32_16x16x16_bf16 v[164:167], v[86:87], v[138:139], 0
  v_mfma_f32_16x16x16_bf16 v[168:171], v[88:89], v[136:137], 0
  v_mfma_f32_16x16x16_bf16 v[172:175], v[90:91], v[138:139], 0
  s_waitcnt vmcnt(13)
  s_barrier
  ds_read_b64_tr_b16 v[224:225], v15 offset:36864
  v_cvt_pk_bf16_f32 v92, v152, v153
  v_cvt_pk_bf16_f32 v93, v154, v155
  ds_read_b64_tr_b16 v[226:227], v15 offset:37376
  ds_write_b64 v24, v[92:93] offset:0
  ds_read_b64_tr_b16 v[228:229], v16 offset:36864
  v_cvt_pk_bf16_f32 v94, v156, v157
  v_cvt_pk_bf16_f32 v95, v158, v159
  ds_read_b64_tr_b16 v[230:231], v16 offset:37376
  ds_write_b64 v24, v[94:95] offset:6144
  ds_read_b64_tr_b16 v[232:233], v17 offset:36864
  v_cvt_pk_bf16_f32 v96, v160, v161
  v_cvt_pk_bf16_f32 v97, v162, v163
  ds_read_b64_tr_b16 v[234:235], v17 offset:37376
  ds_write_b64 v25, v[96:97] offset:0
  ds_read_b64_tr_b16 v[236:237], v18 offset:0
  v_cvt_pk_bf16_f32 v98, v164, v165
  v_cvt_pk_bf16_f32 v99, v166, v167
  ds_read_b64_tr_b16 v[238:239], v18 offset:512
  ds_write_b64 v25, v[98:99] offset:6144
  ds_read_b64_tr_b16 v[240:241], v19 offset:0
  v_cvt_pk_bf16_f32 v100, v168, v169
  v_cvt_pk_bf16_f32 v101, v170, v171
  ds_read_b64_tr_b16 v[242:243], v19 offset:512
  ds_write_b64 v26, v[100:101] offset:0
  ds_read_b64_tr_b16 v[244:245], v20 offset:0
  v_cvt_pk_bf16_f32 v102, v172, v173
  v_cvt_pk_bf16_f32 v103, v174, v175
  ds_read_b64_tr_b16 v[246:247], v20 offset:512
  ds_write_b64 v26, v[102:103] offset:6144
  s_bitcmp1_b32 s99, 1
  s_cbranch_scc0 standalone__video_timesformer__vision_kernel_f_e
  s_add_u32 m0, s32, 24576
  s_nop 0
  buffer_load_dwordx4 v29, s[16:19], s36 offen offset:0 lds
  s_add_u32 m0, s32, 25472
  s_nop 0
  buffer_load_dwordx4 v29, s[16:19], s36 offen offset:128 lds
  s_add_u32 m0, s32, 26368
  s_nop 0
  buffer_load_dwordx4 v29, s[16:19], s36 offen offset:256 lds
  s_add_u32 m0, s32, 36864
  s_add_u32 s46, s37, 0
  buffer_load_dwordx4 v30, s[20:23], s46 offen lds
  s_add_u32 m0, s32, 37888
  s_add_u32 s46, s37, 6144
  buffer_load_dwordx4 v30, s[20:23], s46 offen lds
  s_add_u32 m0, s32, 38912
  s_add_u32 s46, s37, 12288
  buffer_load_dwordx4 v30, s[20:23], s46 offen lds
standalone__video_timesformer__vision_kernel_f_e:
  s_bitcmp1_b32 s99, 1
  s_cbranch_scc1 WR_14
  s_waitcnt vmcnt(2)
WR_14:
  s_waitcnt vmcnt(8)
  v_cmp_ne_u32 vcc, s98, v37
  s_nop 4
  s_cbranch_vccz standalone__video_timesformer__vision_kernel_fk_e
  s_mov_b32 s34, 20000
standalone__video_timesformer__vision_kernel_fk_l:
  buffer_load_dword v37, v40, s[4:7], 0 offen sc1
  s_sub_u32 s34, s34, 1
  s_cbranch_scc1 standalone__video_timesformer__vision_kernel_fk_x
  s_waitcnt vmcnt(0)
  v_cmp_ne_u32 vcc, s98, v37
  s_nop 4
  s_cbranch_vccnz standalone__video_timesformer__vision_kernel_fk_l
standalone__video_timesformer__vision_kernel_fk_x:
  s_waitcnt vmcnt(0)
standalone__video_timesformer__vision_kernel_fk_e:
  s_waitcnt lgkmcnt(0)
  s_barrier
  ds_read_b128 a[0:3], v22 offset:0
  ds_read_b128 a[4:7], v22 offset:6144
  ds_read_b128 a[8:11], v23 offset:0
  ds_read_b128 a[12:15], v23 offset:6144
  ds_read_b64_tr_b16 v[200:201], v18 offset:12288
  ds_read_b64_tr_b16 v[202:203], v18 offset:12800
  ds_read_b64_tr_b16 v[204:205], v19 offset:12288
  ds_read_b64_tr_b16 v[206:207], v19 offset:12800
  ds_read_b64_tr_b16 v[208:209], v20 offset:12288
  ds_read_b64_tr_b16 v[210:211], v20 offset:12800
  ds_read_b128 a[16:19], v22 offset:128
  ds_read_b128 a[20:23], v22 offset:6272
  ds_read_b128 a[24:27], v23 offset:128
  ds_read_b128 a[28:31], v23 offset:6272
  ds_read_b64_tr_b16 v[212:213], v18 offset:24576
  ds_read_b64_tr_b16 v[214:215], v18 offset:25088
  ds_read_b64_tr_b16 v[216:217], v19 offset:24576
  ds_read_b64_tr_b16 v[218:219], v19 offset:25088
  ds_read_b64_tr_b16 v[220:221], v20 offset:24576
  ds_read_b64_tr_b16 v[222:223], v20 offset:25088
  ds_read_b128 a[32:35], v22 offset:256
  ds_read_b128 a[36:39], v22 offset:6400
  ds_read_b128 a[40:43], v23 offset:256
  ds_read_b128 a[44:47], v23 offset:6400
  s_waitcnt lgkmcnt(15)
  v_mfma_f32_16x16x32_bf16 v[176:179], v[224:227], a[0:3], v[176:179]
  s_mul_i32 s45, s28, 18432
  s_add_u32 s45, s45, 3145728
  buffer_load_dwordx4 a[112:115], v36, s[4:7], s45 offen offset:0 sc1
  s_waitcnt lgkmcnt(15)
  v_mfma_f32_16x16x32_bf16 v[180:183], v[224:227], a[4:7], v[180:183]
  v_mfma_f32_16x16x32_bf16 v[184:187], v[228:231], a[0:3], v[184:187]
  buffer_load_dwordx4 a[116:119], v36, s[4:7], s45 offen offset:1024 sc1
  v_mfma_f32_16x16x32_bf16 v[188:191], v[228:231], a[4:7], v[188:191]
  v_mfma_f32_16x16x32_bf16 v[192:195], v[232:235], a[0:3], v[192:195]
  v_mfma_f32_16x16x32_bf16 v[196:199], v[232:235], a[4:7], v[196:199]
  buffer_load_dwordx4 a[120:123], v36, s[4:7], s45 offen offset:2048 sc1
  s_waitcnt lgkmcnt(15)
  v_mfma_f32_16x16x32_bf16 v[176:179], v[236:239], a[8:11], v[176:179]
  s_waitcnt lgkmcnt(15)
  v_mfma_f32_16x16x32_bf16 v[180:183], v[236:239], a[12:15], v[180:183]
  buffer_load_dwordx4 a[124:127], v36, s[4:7], s45 offen offset:3072 sc1
  v_mfma_f32_16x16x32_bf16 v[184:187], v[240:243], a[8:11], v[184:187]
  v_mfma_f32_16x16x32_bf16 v[188:191], v[240:243], a[12:15], v[188:191]
  s_add_u32 s45, s45, 4096
  buffer_load_dwordx4 a[128:131], v36, s[4:7], s45 offen offset:0 sc1
  v_mfma_f32_16x16x32_bf16 v[192:195], v[244:247], a[8:11], v[192:195]
  v_mfma_f32_16x16x32_bf16 v[196:199], v[244:247], a[12:15], v[196:199]
  s_bitcmp1_b32 s99, 1
  s_cbranch_scc1 WR_16
  s_waitcnt vmcnt(5)
WR_16:
  s_waitcnt vmcnt(11)
  s_barrier
  s_waitcnt lgkmcnt(13)
  v_mfma_f32_16x16x32_bf16 v[176:179], v[200:203], a[16:19], v[176:179]
  ds_read_b64_tr_b16 v[224:225], v12 offset:0
  ds_read_b64_tr_b16 v[226:227], v12 offset:512
  buffer_load_dwordx4 a[132:135], v36, s[4:7], s45 offen offset:1024 sc1
  s_waitcnt lgkmcnt(14)
  v_mfma_f32_16x16x32_bf16 v[180:183], v[200:203], a[20:23], v[180:183]
  ds_read_b64_tr_b16 v[228:229], v13 offset:0
  ds_read_b64_tr_b16 v[230:231], v13 offset:512
  v_mfma_f32_16x16x32_bf16 v[184:187], v[204:207], a[16:19], v[184:187]
  ds_read_b64_tr_b16 v[232:233], v14 offset:0
  buffer_load_dwordx4 a[136:139], v36, s[4:7], s45 offen offset:2048 sc1
  v_mfma_f32_16x16x32_bf16 v[188:191], v[204:207], a[20:23], v[188:191]
  ds_read_b64_tr_b16 v[234:235], v14 offset:512
  ds_read_b64_tr_b16 v[236:237], v12 offset:12288
  v_mfma_f32_16x16x32_bf16 v[192:195], v[208:211], a[16:19], v[192:195]
  ds_read_b64_tr_b16 v[238:239], v12 offset:12800
  buffer_load_dwordx4 a[140:143], v36, s[4:7], s45 offen offset:3072 sc1
  ds_read_b64_tr_b16 v[240:241], v13 offset:12288
  v_mfma_f32_16x16x32_bf16 v[196:199], v[208:211], a[20:23], v[196:199]
  ds_read_b64_tr_b16 v[242:243], v13 offset:12800
  s_waitcnt lgkmcnt(15)
  v_mfma_f32_16x16x32_bf16 v[176:179], v[212:215], a[24:27], v[176:179]
  ds_read_b64_tr_b16 v[244:245], v14 offset:12288
  s_add_u32 s45, s45, 4096
  buffer_load_dwordx4 a[144:147], v36, s[4:7], s45 offen offset:0 sc1
  ds_read_b64_tr_b16 v[246:247], v14 offset:12800
  v_mfma_f32_16x16x32_bf16 v[180:183], v[212:215], a[28:31], v[180:183]
  s_waitcnt lgkmcnt(15)
  v_mfma_f32_16x16x32_bf16 v[184:187], v[216:219], a[24:27], v[184:187]
  buffer_load_dwordx4 a[148:151], v36, s[4:7], s45 offen offset:1024 sc1
  v_mfma_f32_16x16x32_bf16 v[188:191], v[216:219], a[28:31], v[188:191]
  s_waitcnt lgkmcnt(15)
  v_mfma_f32_16x16x32_bf16 v[192:195], v[220:223], a[24:27], v[192:195]
  buffer_load_dwordx4 a[152:155], v36, s[4:7], s45 offen offset:2048 sc1
  v_mfma_f32_16x16x32_bf16 v[196:199], v[220:223], a[28:31], v[196:199]
  s_waitcnt lgkmcnt(10)
  v_mfma_f32_16x16x32_bf16 v[176:179], v[224:227], a[32:35], v[176:179]
  buffer_load_dwordx4 a[156:159], v36, s[4:7], s45 offen offset:3072 sc1
  v_mfma_f32_16x16x32_bf16 v[180:183], v[224:227], a[36:39], v[180:183]
  s_waitcnt lgkmcnt(8)
  v_mfma_f32_16x16x32_bf16 v[184:187], v[228:231], a[32:35], v[184:187]
  v_mfma_f32_16x16x32_bf16 v[188:191], v[228:231], a[36:39], v[188:191]
  s_add_u32 s45, s45, 4096
  buffer_load_dwordx4 a[160:163], v36, s[4:7], s45 offen offset:0 sc1
  s_waitcnt lgkmcnt(6)
  v_mfma_f32_16x16x32_bf16 v[192:195], v[232:235], a[32:35], v[192:195]
  v_mfma_f32_16x16x32_bf16 v[196:199], v[232:235], a[36:39], v[196:199]
  s_waitcnt lgkmcnt(4)
  v_mfma_f32_16x16x32_bf16 v[176:179], v[236:239], a[40:43], v[176:179]
  buffer_load_dwordx4 a[164:167], v36, s[4:7], s45 offen offset:1024 sc1
  v_mfma_f32_16x16x32_bf16 v[180:183], v[236:239], a[44:47], v[180:183]
  s_waitcnt lgkmcnt(2)
  v_mfma_f32_16x16x32_bf16 v[184:187], v[240:243], a[40:43], v[184:187]
  v_mfma_f32_16x16x32_bf16 v[188:191], v[240:243], a[44:47], v[188:191]
  buffer_load_dwordx4 a[168:171], v36, s[4:7], s45 offen offset:2048 sc1
  s_waitcnt lgkmcnt(0)
  v_mfma_f32_16x16x32_bf16 v[192:195], v[244:247], a[40:43], v[192:195]
  v_mfma_f32_16x16x32_bf16 v[196:199], v[244:247], a[44:47], v[196:199]
  v_cvt_pk_bf16_f32 v80, v176, v177
  v_cvt_pk_bf16_f32 v81, v178, v179
  ds_write_b64 v24, v[80:81] offset:0
  v_cvt_pk_bf16_f32 v82, v180, v181
  v_cvt_pk_bf16_f32 v83, v182, v183
  ds_write_b64 v24, v[82:83] offset:6144
  buffer_load_dwordx4 a[172:175], v36, s[4:7], s45 offen offset:3072 sc1
  v_cvt_pk_bf16_f32 v84, v184, v185
  v_cvt_pk_bf16_f32 v85, v186, v187
  ds_write_b64 v25, v[84:85] offset:0
  v_cvt_pk_bf16_f32 v86, v188, v189
  s_add_u32 s45, s45, 4096
  buffer_load_dwordx4 a[176:179], v36, s[4:7], s45 offen offset:0 sc1
  v_cvt_pk_bf16_f32 v87, v190, v191
  ds_write_b64 v25, v[86:87] offset:6144
  v_cvt_pk_bf16_f32 v88, v192, v193
  v_cvt_pk_bf16_f32 v89, v194, v195
  buffer_load_dwordx4 a[180:183], v36, s[4:7], s45 offen offset:1024 sc1
  ds_write_b64 v26, v[88:89] offset:0
  v_cvt_pk_bf16_f32 v90, v196, v197
  v_cvt_pk_bf16_f32 v91, v198, v199
  ds_write_b64 v26, v[90:91] offset:6144
  v_mov_b32 v46, 0
  v_mov_b32 v44, 0
  v_mov_b32 v48, 0
  v_mov_b32 v49, 0
  s_bitcmp1_b32 s99, 1
  s_cbranch_scc0 standalone__video_timesformer__vision_kernel_ww
  s_waitcnt vmcnt(18)
standalone__video_timesformer__vision_kernel_ww:
  s_waitcnt lgkmcnt(0)
  s_barrier
  ds_read_b128 v[80:83], v21 offset:0
  ds_read_b128 v[84:87], v21 offset:128
  ds_read_b128 v[88:91], v21 offset:256
  s_add_u32 s33, s43, 4096
  s_add_u32 s34, s43, 8192
  s_waitcnt lgkmcnt(2)
  v_dot2c_f32_bf16 v46, v80, v31
  v_dot2c_f32_bf16 v44, v80, v80
  v_dot2c_f32_bf16 v48, v81, v31
  v_dot2c_f32_bf16 v49, v81, v81
  v_dot2c_f32_bf16 v46, v82, v31
  v_dot2c_f32_bf16 v44, v82, v82
  v_dot2c_f32_bf16 v48, v83, v31
  v_dot2c_f32_bf16 v49, v83, v83
  s_waitcnt lgkmcnt(1)
  v_dot2c_f32_bf16 v46, v84, v31
  v_dot2c_f32_bf16 v44, v84, v84
  v_dot2c_f32_bf16 v48, v85, v31
  v_dot2c_f32_bf16 v49, v85, v85
  v_dot2c_f32_bf16 v46, v86, v31
  v_dot2c_f32_bf16 v44, v86, v86
  v_dot2c_f32_bf16 v48, v87, v31
  v_dot2c_f32_bf16 v49, v87, v87
  s_waitcnt lgkmcnt(0)
  v_dot2c_f32_bf16 v46, v88, v31
  v_dot2c_f32_bf16 v44, v88, v88
  v_dot2c_f32_bf16 v48, v89, v31
  v_dot2c_f32_bf16 v49, v89, v89
  v_dot2c_f32_bf16 v46, v90, v31
  v_dot2c_f32_bf16 v44, v90, v90
  v_dot2c_f32_bf16 v48, v91, v31
  v_dot2c_f32_bf16 v49, v91, v91
  s_nop 1
  v_add_f32 v46, v46, v48
  v_add_f32 v44, v44, v49
  s_nop 0
  v_add_f32_dpp v46, v46, v46 quad_perm:[1,0,3,2] row_mask:0xf bank_mask:0xf
  v_lshlrev_b32 v200, 16, v80
  v_and_b32 v201, 0xffff0000, v80
  v_add_f32_dpp v44, v44, v44 quad_perm:[1,0,3,2] row_mask:0xf bank_mask:0xf
  v_lshlrev_b32 v202, 16, v81
  v_add_f32_dpp v46, v46, v46 quad_perm:[2,3,0,1] row_mask:0xf bank_mask:0xf
  v_and_b32 v203, 0xffff0000, v81
  v_lshlrev_b32 v204, 16, v82
  v_add_f32_dpp v44, v44, v44 quad_perm:[2,3,0,1] row_mask:0xf bank_mask:0xf
  v_and_b32 v205, 0xffff0000, v82
  v_add_f32_dpp v46, v46, v46 row_half_mirror row_mask:0xf bank_mask:0xf
  v_lshlrev_b32 v206, 16, v83
  v_and_b32 v207, 0xffff0000, v83
  v_add_f32_dpp v44, v44, v44 row_half_mirror row_mask:0xf bank_mask:0xf
  v_lshlrev_b32 v208, 16, v84
  v_mul_f32 v46, 0x3baaaaab, v46
  v_and_b32 v209, 0xffff0000, v84
  v_mov_b32 v49, 0x3727c5ac
  v_lshlrev_b32 v210, 16, v85
  v_and_b32 v211, 0xffff0000, v85
  v_fmac_f32 v49, 0x3baaaaab, v44
  v_lshlrev_b32 v212, 16, v86
  v_mul_f32 v48, v46, v46
  v_and_b32 v213, 0xffff0000, v86
  v_lshlrev_b32 v214, 16, v87
  v_sub_f32 v44, v49, v48
  v_and_b32 v215, 0xffff0000, v87
  v_max_f32 v44, 0x3727c5ac, v44
  v_lshlrev_b32 v216, 16, v88
  v_sqrt_f32 v56, v44
  v_and_b32 v217, 0xffff0000, v88
  v_lshlrev_b32 v218, 16, v89
  v_mov_b32 v57, v46
  v_and_b32 v219, 0xffff0000, v89
  v_rsq_f32 v44, v44
  v_lshlrev_b32 v220, 16, v90
  v_and_b32 v221, 0xffff0000, v90
  v_mul_f32 v46, v46, v44
  v_lshlrev_b32 v222, 16, v91
  v_sub_f32 v46, 0, v46
  v_and_b32 v223, 0xffff0000, v91
  buffer_store_dwordx2 v[56:57], v33, s[4:7], s44 offen sc1
  v_pk_fma_f32 v[200:201], v[200:201], v[44:45], v[46:47] op_sel_hi:[1,0,0]
  v_cvt_pk_bf16_f32 v92, v200, v201
  v_pk_fma_f32 v[202:203], v[202:203], v[44:45], v[46:47] op_sel_hi:[1,0,0]
  v_cvt_pk_bf16_f32 v93, v202, v203
  v_pk_fma_f32 v[204:205], v[204:205], v[44:45], v[46:47] op_sel_hi:[1,0,0]
  v_cvt_pk_bf16_f32 v94, v204, v205
  v_pk_fma_f32 v[206:207], v[206:207], v[44:45], v[46:47] op_sel_hi:[1,0,0]
  v_cvt_pk_bf16_f32 v95, v206, v207
  buffer_store_dwordx4 v[92:95], v3, s[4:7], s43 offen sc1
  v_pk_fma_f32 v[208:209], v[208:209], v[44:45], v[46:47] op_sel_hi:[1,0,0]
  v_cvt_pk_bf16_f32 v96, v208, v209
  v_pk_fma_f32 v[210:211], v[210:211], v[44:45], v[46:47] op_sel_hi:[1,0,0]
  v_cvt_pk_bf16_f32 v97, v210, v211
  v_pk_fma_f32 v[212:213], v[212:213], v[44:45], v[46:47] op_sel_hi:[1,0,0]
  v_cvt_pk_bf16_f32 v98, v212, v213
  v_pk_fma_f32 v[214:215], v[214:215], v[44:45], v[46:47] op_sel_hi:[1,0,0]
  v_cvt_pk_bf16_f32 v99, v214, v215
  buffer_store_dwordx4 v[96:99], v3, s[4:7], s33 offen sc1
  v_pk_fma_f32 v[216:217], v[216:217], v[44:45], v[46:47] op_sel_hi:[1,0,0]
  v_cvt_pk_bf16_f32 v100, v216, v217
  v_pk_fma_f32 v[218:219], v[218:219], v[44:45], v[46:47] op_sel_hi:[1,0,0]
  v_cvt_pk_bf16_f32 v101, v218, v219
  v_pk_fma_f32 v[220:221], v[220:221], v[44:45], v[46:47] op_sel_hi:[1,0,0]
  v_cvt_pk_bf16_f32 v102, v220, v221
  v_pk_fma_f32 v[222:223], v[222:223], v[44:45], v[46:47] op_sel_hi:[1,0,0]
  v_cvt_pk_bf16_f32 v103, v222, v223
  buffer_store_dwordx4 v[100:103], v3, s[4:7], s34 offen sc1
  v_lshlrev_b32 v39, 5, v1
  s_lshr_b32 s33, s2, 3
  v_add_u32 v39, s33, v39
  v_mul_u32_u24 v39, 256, v39
  v_add_u32 v39, 3670016, v39
  s_waitcnt vmcnt(22)
  v_mov_b32 v37, 1
  s_waitcnt vmcnt(0)
  s_barrier
  s_cmp_lg_u32 s28, 0
  s_cbranch_scc1 standalone__video_timesformer__vision_kernel_pb
  s_mov_b64 exec, 0xff
  buffer_atomic_add v37, v39, s[4:7], 0 offen sc1
  s_mov_b64 exec, -1
standalone__video_timesformer__vision_kernel_pb:
  s_bitcmp1_b32 s99, 1
  s_cbranch_scc0 standalone__video_timesformer__vision_kernel_fa
  s_mul_i32 s38, s3, 171
  s_lshr_b32 s38, s38, 10
  s_mul_i32 s34, s38, 6
  s_sub_u32 s39, s3, s34
  s_and_b32 s35, s28, 1
  s_lshl_b32 s33, s38, 1
  s_add_u32 s33, s33, s35
  s_lshr_b32 s34, s28, 1
  v_lshrrev_b32 v65, 4, v1
  v_and_b32 v66, 15, v1
  v_and_b32 v67, 7, v1
  v_xor_b32 v64, v65, v67
  v_lshlrev_b32 v64, 4, v64
  v_lshl_add_u32 v64, v67, 7, v64
  v_lshrrev_b32 v67, 3, v66
  v_mul_u32_u24 v67, 3072, v67
  v_add_u32 v64, v64, v67
  s_mul_i32 s35, s35, 6144
  s_add_u32 s35, s35, 24576
  v_add_u32 v68, s35, v64
  v_xor_b32 v69, 64, v68
  ds_read_b128 a[48:51], v68 offset:0
  ds_read_b128 a[52:55], v69 offset:0
  ds_read_b128 a[56:59], v68 offset:1024
  ds_read_b128 a[60:63], v69 offset:1024
  ds_read_b128 a[64:67], v68 offset:2048
  ds_read_b128 a[68:71], v69 offset:2048
  s_cmp_ge_u32 s39, 3
  s_cselect_b32 s35, 1, 0
  s_mul_i32 s45, s35, 3
  s_sub_u32 s45, s39, s45
  s_lshl_b32 s35, s35, 1
  s_lshr_b32 s46, s45, 1
  s_cmp_eq_u32 s45, 1
  s_cselect_b32 s46, s34, s46
  s_cselect_b32 s47, 2, s34
  s_add_u32 s35, s35, s46
  s_mul_i32 s35, s35, 3
  s_add_u32 s35, s35, s47
  s_mul_i32 s40, s35, 6144
  s_cmp_eq_u32 s45, 1
  s_cselect_b32 s46, 8, 16
  s_cselect_b32 s47, 32, 8
  s_mul_i32 s47, s47, s34
  s_add_u32 s47, s47, 36864
  v_bfe_u32 v67, v1, 2, 2
  v_lshl_add_u32 v67, v65, 3, v67
  v_lshlrev_b32 v67, 6, v67
  v_and_b32 v70, 3, v1
  v_mul_u32_u24 v70, s46, v70
  v_add3_u32 v70, v67, v70, s47
  ds_read_b64_tr_b16 a[72:73], v70 offset:0
  ds_read_b64_tr_b16 a[74:75], v70 offset:256
  ds_read_b64_tr_b16 a[76:77], v70 offset:2048
  ds_read_b64_tr_b16 a[78:79], v70 offset:2304
  ds_read_b64_tr_b16 a[80:81], v70 offset:4096
  ds_read_b64_tr_b16 a[82:83], v70 offset:4352
  ds_read_b64_tr_b16 a[84:85], v70 offset:6144
  ds_read_b64_tr_b16 a[86:87], v70 offset:6400
  ds_read_b64_tr_b16 a[88:89], v70 offset:8192
  ds_read_b64_tr_b16 a[90:91], v70 offset:8448
  ds_read_b64_tr_b16 a[92:93], v70 offset:10240
  ds_read_b64_tr_b16 a[94:95], v70 offset:10496
  s_mul_i32 s35, s33, 171
  s_lshr_b32 s35, s35, 9
  s_mul_i32 s45, s35, 3
  s_sub_u32 s45, s33, s45
  s_lshl_b32 s46, s35, 10
  s_lshl_b32 s47, s45, 3
  s_add_u32 s46, s46, s47
  s_lshr_b32 s47, s35, 1
  s_lshl_b32 s47, s47, 10
  s_add_u32 s47, s47, 4096
  s_and_b32 s35, s35, 1
  s_lshl_b32 s35, s35, 3
  s_add_u32 s47, s47, s35
  s_cmp_eq_u32 s45, 2
  s_cselect_b32 s46, s47, s46
  s_add_u32 s40, s40, s46
  s_add_u32 s40, s40, 3276800
  v_lshlrev_b32 v67, 4, v1
  s_waitcnt lgkmcnt(10)
  v_mfma_f32_16x16x32_bf16 v[72:75], a[48:51], a[72:75], 0
  s_waitcnt lgkmcnt(8)
  v_mfma_f32_16x16x32_bf16 v[72:75], a[52:55], a[76:79], v[72:75]
  s_waitcnt lgkmcnt(6)
  v_mfma_f32_16x16x32_bf16 v[72:75], a[56:59], a[80:83], v[72:75]
  s_waitcnt lgkmcnt(4)
  v_mfma_f32_16x16x32_bf16 v[72:75], a[60:63], a[84:87], v[72:75]
  s_waitcnt lgkmcnt(2)
  v_mfma_f32_16x16x32_bf16 v[72:75], a[64:67], a[88:91], v[72:75]
  s_waitcnt lgkmcnt(0)
  v_mfma_f32_16x16x32_bf16 v[72:75], a[68:71], a[92:95], v[72:75]
  s_nop 7
  v_cvt_pk_bf16_f32 v76, v72, v73
  v_cvt_pk_bf16_f32 v77, v74, v75
  buffer_store_dwordx2 v[76:77], v67, s[4:7], s40 offen sc1
standalone__video_timesformer__vision_kernel_fa:
  s_nop 1
ts_b:
  s_load_dwordx2 s[8:9], s[0:1], 40
  v_mov_b32 v193, 0
  s_and_b32 s92, s2, 7
  s_lshl_b32 s92, s92, 5
  v_add_u32 v195, s92, v1
  v_mul_u32_u24 v195, 256, v195
  v_add_u32 v195, 3670016, v195
  v_lshrrev_b32 v112, 6, v0
  v_and_b32 v1, 63, v0
  v_readfirstlane_b32 s12, v112
  v_lshlrev_b32 v2, 4, v1
  s_mul_i32 s88, s12, 18432
  s_add_u32 s88, s88, 3276800
  s_mov_b32 s10, 3145728
  s_mov_b32 s11, 0x00020000
  s_and_b32 s13, s2, 7
  s_lshr_b32 s14, s2, 3
  s_mul_i32 s21, s13, 393216
  s_mul_i32 s17, s14, 12288
  s_add_u32 s22, s21, s17
  s_lshl_b32 s17, s12, 12
  s_sub_u32 s17, s17, 4096
  s_add_u32 s15, s22, s17
  s_add_u32 s90, s17, 24576
  s_lshl_b32 s89, s13, 13
  s_lshl_b32 s18, s14, 8
  s_add_u32 s89, s89, s18
  s_add_u32 s89, s89, 3407872
  v_and_b32 v90, 15, v1
  v_lshlrev_b32 v90, 3, v90
  s_mul_i32 s16, s12, 40960
  s_and_b32 s20, s14, 7
  s_mul_i32 s17, s12, 98304
  s_add_u32 s21, s21, s17
  s_add_u32 s92, s20, 0
  s_and_b32 s92, s92, 7
  s_mul_i32 s92, s92, 12288
  s_add_u32 s24, s92, s21
  s_add_u32 s25, s24, 4096
  s_add_u32 s26, s24, 8192
  s_add_u32 s92, s20, 1
  s_and_b32 s92, s92, 7
  s_mul_i32 s92, s92, 12288
  s_add_u32 s27, s92, s21
  s_add_u32 s28, s27, 4096
  s_add_u32 s29, s27, 8192
  s_add_u32 s92, s20, 2
  s_and_b32 s92, s92, 7
  s_mul_i32 s92, s92, 12288
  s_add_u32 s30, s92, s21
  s_add_u32 s31, s30, 4096
  s_add_u32 s32, s30, 8192
  s_add_u32 s92, s20, 3
  s_and_b32 s92, s92, 7
  s_mul_i32 s92, s92, 12288
  s_add_u32 s33, s92, s21
  s_add_u32 s34, s33, 4096
  s_add_u32 s35, s33, 8192
  s_add_u32 s92, s20, 4
  s_and_b32 s92, s92, 7
  s_mul_i32 s92, s92, 12288
  s_add_u32 s36, s92, s21
  s_add_u32 s37, s36, 4096
  s_add_u32 s38, s36, 8192
  s_add_u32 s92, s20, 5
  s_and_b32 s92, s92, 7
  s_mul_i32 s92, s92, 12288
  s_add_u32 s39, s92, s21
  s_add_u32 s40, s39, 4096
  s_add_u32 s41, s39, 8192
  s_add_u32 s92, s20, 6
  s_and_b32 s92, s92, 7
  s_mul_i32 s92, s92, 12288
  s_add_u32 s42, s92, s21
  s_add_u32 s43, s42, 4096
  s_add_u32 s44, s42, 8192
  s_add_u32 s92, s20, 7
  s_and_b32 s92, s92, 7
  s_mul_i32 s92, s92, 12288
  s_add_u32 s45, s92, s21
  s_add_u32 s46, s45, 4096
  s_add_u32 s47, s45, 8192
  v_and_b32 v112, 31, v1
  v_lshrrev_b32 v113, 5, v1
  v_and_b32 v114, 15, v1
  v_lshrrev_b32 v115, 4, v1
  v_bfe_u32 v116, v1, 2, 2
  v_and_b32 v117, 3, v1
  v_and_b32 v122, 1, v115
  v_bfe_u32 v119, v1, 1, 1
  v_lshl_or_b32 v118, v119, 2, v116
  v_lshlrev_b32 v120, 7, v114
  v_add_u32 v120, 24576, v120
  v_add_u32 v119, 0, v115
  v_xor_b32 v119, v119, v118
  v_lshl_add_u32 v80, v119, 4, v120
  v_add_u32 v119, 4, v115
  v_xor_b32 v119, v119, v118
  v_lshl_add_u32 v81, v119, 4, v120
  s_and_b32 s19, s12, 1
  s_mul_i32 s17, s12, 6
  s_lshl_b32 s18, s19, 1
  s_add_u32 s18, s18, s17
  s_and_b32 s23, s18, 7
  v_add_u32 v119, s23, v115
  v_xor_b32 v119, v119, v118
  v_lshl_add_u32 v88, v119, 4, v120
  s_lshr_b32 s18, s18, 3
  s_lshl_b32 s18, s18, 12
  v_add_u32 v88, s18, v88
  s_lshl_b32 s18, s19, 2
  s_sub_u32 s18, s17, s18
  s_add_u32 s18, s18, 4
  s_and_b32 s23, s18, 7
  v_add_u32 v119, s23, v113
  v_xor_b32 v119, v119, v118
  v_lshl_add_u32 v89, v119, 4, v120
  v_lshl_add_u32 v89, v122, 3, v89
  s_lshr_b32 s18, s18, 3
  s_lshl_b32 s18, s18, 12
  v_add_u32 v89, s18, v89
  s_add_u32 s18, s16, 36864
  v_lshl_add_u32 v119, v113, 5, v114
  v_lshlrev_b32 v119, 4, v119
  v_lshl_add_u32 v119, v122, 3, v119
  v_add_u32 v84, s18, v119
  v_add_u32 v85, 36864, v2
  v_add_u32 v86, 118784, v2
  s_lshl_b32 s18, s12, 2
  s_add_u32 s18, s18, 162816
  v_lshlrev_b32 v119, 4, v114
  v_add_u32 v87, s18, v119
  v_lshlrev_b32 v119, 4, v112
  v_add_u32 v11, 162816, v119
  v_lshlrev_b32 v120, 7, v112
  v_add_u32 v120, s16, v120
  v_add_u32 v119, 0, v113
  v_xor_b32 v119, v119, v118
  v_lshl_add_u32 v3, v119, 4, v120
  v_add_u32 v119, 2, v113
  v_xor_b32 v119, v119, v118
  v_lshl_add_u32 v4, v119, 4, v120
  v_add_u32 v119, 4, v113
  v_xor_b32 v119, v119, v118
  v_lshl_add_u32 v5, v119, 4, v120
  v_add_u32 v119, 6, v113
  v_xor_b32 v119, v119, v118
  v_lshl_add_u32 v6, v119, 4, v120
  v_lshlrev_b32 v120, 2, v113
  v_add_u32 v120, v120, v116
  v_lshlrev_b32 v120, 7, v120
  v_add_u32 v120, s16, v120
  v_and_b32 v121, 1, v117
  v_lshl_add_u32 v120, v121, 3, v120
  v_lshlrev_b32 v121, 1, v122
  v_lshrrev_b32 v119, 1, v117
  v_add_u32 v121, v121, v119
  v_lshrrev_b32 v119, 1, v116
  v_lshl_or_b32 v119, v119, 2, v113
  v_xor_b32 v121, v121, v119
  v_xor_b32 v119, 0, v121
  v_lshl_add_u32 v119, v119, 4, v120
  v_add_u32 v7, 0, v119
  v_xor_b32 v119, 2, v121
  v_lshl_add_u32 v119, v119, 4, v120
  v_add_u32 v8, 1024, v119
  v_xor_b32 v119, 4, v121
  v_lshl_add_u32 v119, v119, 4, v120
  v_add_u32 v9, 0, v119
  v_xor_b32 v119, 6, v121
  v_lshl_add_u32 v119, v119, 4, v120
  v_add_u32 v10, 1024, v119
  v_mov_b32 v22, 0
  v_mov_b32 v23, 0
  s_and_b32 s19, s12, 1
  s_mul_i32 s17, s12, 96
  s_lshl_b32 s18, s19, 5
  s_add_u32 s18, s18, s17
  v_mul_u32_u24 v119, 384, v114
  v_lshl_add_u32 v17, v115, 4, v119
  v_add_u32 v17, s18, v17
  s_lshl_b32 s18, s19, 6
  s_sub_u32 s18, s17, s18
  s_add_u32 s18, s18, 64
  v_lshl_add_u32 v18, v115, 3, v119
  v_add_u32 v18, s18, v18
  s_add_u32 s18, s16, 16384
  v_add_u32 v14, s18, v2
  s_mul_i32 s17, s12, 3072
  s_add_u32 s17, s17, 16384
  v_lshl_add_u32 v119, v122, 5, v114
  v_lshlrev_b32 v119, 4, v119
  v_mul_u32_u24 v121, 40960, v113
  v_add3_u32 v12, v119, v121, s17
  v_add_u32 v13, 81920, v12
  s_lshl_b32 s17, s12, 11
  v_add_u32 v15, s17, v2
  s_lshr_b32 s17, s12, 1
  s_lshl_b32 s17, s17, 11
  s_lshl_b32 s18, s19, 3
  s_add_u32 s17, s17, s18
  s_add_u32 s17, s17, 8192
  v_add_u32 v16, s17, v2
  s_add_u32 s18, s16, 28672
  v_lshlrev_b32 v119, 2, v112
  v_add_u32 v19, s18, v119
  v_mul_u32_u24 v119, 40960, v115
  v_lshl_add_u32 v119, v114, 2, v119
  v_add_u32 v20, 28672, v119
  v_and_b32 v119, 1, v1
  v_lshlrev_b32 v119, 4, v119
  v_mov_b32 v120, 0x3f80
  v_lshlrev_b32 v119, v119, v120
  v_bfe_u32 v120, v1, 2, 1
  v_cmp_eq_u32 vcc, v120, v122
  s_nop 1
  v_cndmask_b32 v119, 0, v119, vcc
  v_bfe_u32 v120, v1, 3, 1
  v_bfe_u32 v121, v1, 1, 1
  v_lshl_add_u32 v120, v120, 1, v121
  v_cmp_eq_u32 vcc, 0, v120
  s_nop 1
  v_cndmask_b32 v121, 0, v119, vcc
  v_mov_b32 v248, v121
  v_cmp_eq_u32 vcc, 1, v120
  s_nop 1
  v_cndmask_b32 v121, 0, v119, vcc
  v_mov_b32 v249, v121
  v_cmp_eq_u32 vcc, 2, v120
  s_nop 1
  v_cndmask_b32 v121, 0, v119, vcc
  v_mov_b32 v250, v121
  v_cmp_eq_u32 vcc, 3, v120
  s_nop 1
  v_cndmask_b32 v121, 0, v119, vcc
  v_mov_b32 v251, v121
  v_min_u32 v21, 35, v1
  v_lshlrev_b32 v21, 4, v21
  v_add_u32 v21, 3481600, v21
  v_mov_b32 v192, s98
  s_mov_b32 s93, 20000
  s_cmp_lg_u32 s12, 0
  s_cbranch_scc1 ts_b_gw
  s_mov_b64 exec, 0xffffffff
  buffer_atomic_umax v193, v195, s[4:7], 0 offen sc0 sc1
ts_b_g1:
  s_waitcnt vmcnt(0)
  v_cmp_ne_u32 vcc, 8, v193
  s_nop 4
  s_mov_b64 exec, vcc
  s_bitcmp1_b32 vcc_lo, s14
  s_cbranch_scc0 ts_b_g2
  s_sub_u32 s93, s93, 1
  s_cbranch_scc1 ts_b_g2
  buffer_atomic_umax v193, v195, s[4:7], 0 offen sc0 sc1
  s_waitcnt vmcnt(0)
  v_cmp_ne_u32 vcc, 8, v193
  s_nop 4
  s_mov_b64 exec, vcc
  s_bitcmp1_b32 vcc_lo, s14
  s_cbranch_scc0 ts_b_g2
  s_lshl_b32 s92, 1, s14
  s_mov_b32 exec_lo, s92
ts_b_g1o:
  buffer_atomic_umax v193, v195, s[4:7], 0 offen sc0 sc1
  s_waitcnt vmcnt(0)
  v_cmp_ne_u32 s[18:19], 8, v193
  s_nop 4
  s_cmp_eq_u32 s18, 0
  s_cbranch_scc1 ts_b_g1x
  s_sub_u32 s93, s93, 1
  s_cbranch_scc0 ts_b_g1o
ts_b_g1x:
  s_andn2_b32 vcc_lo, vcc_lo, s92
  s_mov_b64 exec, vcc
ts_b_g2:
  s_cbranch_execz ts_b_g2b
  buffer_atomic_umax v193, v195, s[4:7], 0 offen sc0 sc1
ts_b_g2b:
  s_barrier
  s_mov_b32 s93, 20000
  s_mov_b64 exec, -1
  buffer_load_dwordx2 v[236:237], v90, s[4:7], s89 offen offset:0 sc1
  buffer_load_dwordx2 v[238:239], v90, s[4:7], s89 offen offset:128 sc1
  s_mov_b64 exec, vcc
  s_cbranch_execz ts_b_g4
  s_waitcnt vmcnt(2)
  s_branch ts_b_g3c
ts_b_g3:
  s_sub_u32 s93, s93, 1
  s_cbranch_scc1 ts_b_g4
  buffer_atomic_umax v193, v195, s[4:7], 0 offen sc0 sc1
  s_waitcnt vmcnt(0)
ts_b_g3c:
  v_cmp_ne_u32 vcc, 8, v193
  s_nop 4
  s_mov_b64 exec, vcc
  s_cbranch_vccnz ts_b_g3
ts_b_g4:
  s_mov_b64 exec, -1
  s_branch ts_b_gj
ts_b_gw:
  s_barrier
  s_mov_b32 m0, s90
  s_nop 0
  buffer_load_dwordx4 v2, s[4:7], s15 offen offset:0 sc1 lds
  buffer_load_dwordx4 v2, s[4:7], s15 offen offset:1024 sc1 lds
  buffer_load_dwordx4 v2, s[4:7], s15 offen offset:2048 sc1 lds
  buffer_load_dwordx4 v2, s[4:7], s15 offen offset:3072 sc1 lds
  buffer_load_dwordx2 v[236:237], v90, s[4:7], s89 offen offset:0 sc1
  buffer_load_dwordx2 v[238:239], v90, s[4:7], s89 offen offset:128 sc1
ts_b_gj:
  s_barrier
  s_add_u32 m0, s16, 0
  s_nop 0
  buffer_load_dwordx4 v2, s[4:7], s24 offen offset:0 sc1 lds
  buffer_load_dwordx4 v2, s[4:7], s24 offen offset:1024 sc1 lds
  buffer_load_dwordx4 v2, s[4:7], s24 offen offset:2048 sc1 lds
  buffer_load_dwordx4 v2, s[4:7], s24 offen offset:3072 sc1 lds
  s_add_u32 m0, s16, 4096
  s_nop 0
  buffer_load_dwordx4 v2, s[4:7], s25 offen offset:0 sc1 lds
  buffer_load_dwordx4 v2, s[4:7], s25 offen offset:1024 sc1 lds
  buffer_load_dwordx4 v2, s[4:7], s25 offen offset:2048 sc1 lds
  buffer_load_dwordx4 v2, s[4:7], s25 offen offset:3072 sc1 lds
  s_add_u32 m0, s16, 8192
  s_nop 0
  buffer_load_dwordx4 v2, s[4:7], s26 offen offset:0 sc1 lds
  buffer_load_dwordx4 v2, s[4:7], s26 offen offset:1024 sc1 lds
  s_waitcnt vmcnt(10)
  s_barrier
  ds_read_b128 v[32:35], v80 offset:0
  ds_read_b128 v[36:39], v80 offset:2048
  ds_read_b128 v[40:43], v81 offset:0
  ds_read_b128 v[44:47], v81 offset:2048
  s_or_b32 s17, s2, s12
  s_cmp_lg_u32 s17, 0
  s_cbranch_scc1 ts_b_ep
  s_mov_b32 s17, 3473408
  s_mov_b64 exec, 1
  buffer_store_dword v192, off, s[4:7], s17 sc1
  s_mov_b64 exec, -1
ts_b_ep:
  s_bitcmp1_b32 s99, 1
  s_cbranch_scc0 ts_b_wf
  s_cmp_lg_u32 s12, 1
  s_cbranch_scc1 ts_b_wf
  s_lshl_b32 s17, s3, 4
  s_add_u32 s17, s17, 3481600
  s_mov_b64 exec, 1
  buffer_store_dword v192, off, s[4:7], s17 sc1
  s_mov_b64 exec, -1
ts_b_wf:
  s_waitcnt lgkmcnt(3)
  v_mfma_f32_16x16x32_bf16 v[128:131], a[112:115], v[32:35], 0
  s_waitcnt lgkmcnt(2)
  v_mfma_f32_16x16x32_bf16 v[132:135], a[112:115], v[36:39], 0
  ds_read_b128 v[48:51], v80 offset:4096
  v_mfma_f32_16x16x32_bf16 v[136:139], a[136:139], v[32:35], 0
  v_mfma_f32_16x16x32_bf16 v[140:143], a[136:139], v[36:39], 0
  ds_read_b128 v[52:55], v80 offset:6144
  s_waitcnt lgkmcnt(3)
  v_mfma_f32_16x16x32_bf16 v[128:131], a[116:119], v[40:43], v[128:131]
  s_waitcnt lgkmcnt(2)
  v_mfma_f32_16x16x32_bf16 v[132:135], a[116:119], v[44:47], v[132:135]
  ds_read_b128 v[56:59], v81 offset:4096
  v_mfma_f32_16x16x32_bf16 v[136:139], a[140:143], v[40:43], v[136:139]
  v_mfma_f32_16x16x32_bf16 v[140:143], a[140:143], v[44:47], v[140:143]
  ds_read_b128 v[60:63], v81 offset:6144
  s_waitcnt lgkmcnt(3)
  v_mfma_f32_16x16x32_bf16 v[128:131], a[120:123], v[48:51], v[128:131]
  s_waitcnt lgkmcnt(2)
  v_mfma_f32_16x16x32_bf16 v[132:135], a[120:123], v[52:55], v[132:135]
  ds_read_b128 v[64:67], v80 offset:8192
  v_mfma_f32_16x16x32_bf16 v[136:139], a[144:147], v[48:51], v[136:139]
  v_mfma_f32_16x16x32_bf16 v[140:143], a[144:147], v[52:55], v[140:143]
  ds_read_b128 v[68:71], v80 offset:10240
  s_waitcnt lgkmcnt(3)
  v_mfma_f32_16x16x32_bf16 v[128:131], a[124:127], v[56:59], v[128:131]
  s_waitcnt lgkmcnt(2)
  v_mfma_f32_16x16x32_bf16 v[132:135], a[124:127], v[60:63], v[132:135]
  ds_read_b128 v[72:75], v81 offset:8192
  v_mfma_f32_16x16x32_bf16 v[136:139], a[148:151], v[56:59], v[136:139]
  v_mfma_f32_16x16x32_bf16 v[140:143], a[148:151], v[60:63], v[140:143]
  ds_read_b128 v[76:79], v81 offset:10240
  s_waitcnt lgkmcnt(3)
  v_mfma_f32_16x16x32_bf16 v[128:131], a[128:131], v[64:67], v[128:131]
  s_waitcnt lgkmcnt(2)
  v_mfma_f32_16x16x32_bf16 v[132:135], a[128:131], v[68:71], v[132:135]
  ds_read_b128 v[224:227], v88 offset:0
  v_mfma_f32_16x16x32_bf16 v[136:139], a[152:155], v[64:67], v[136:139]
  v_mfma_f32_16x16x32_bf16 v[140:143], a[152:155], v[68:71], v[140:143]
  ds_read_b64 v[232:233], v89 offset:0
  buffer_load_dwordx4 v2, s[4:7], s26 offen offset:2048 sc1 lds
  s_waitcnt lgkmcnt(3)
  v_mfma_f32_16x16x32_bf16 v[128:131], a[132:135], v[72:75], v[128:131]
  s_waitcnt lgkmcnt(2)
  v_mfma_f32_16x16x32_bf16 v[132:135], a[132:135], v[76:79], v[132:135]
  ds_read_b128 v[228:231], v88 offset:2048
  v_mfma_f32_16x16x32_bf16 v[136:139], a[156:159], v[72:75], v[136:139]
  v_mfma_f32_16x16x32_bf16 v[140:143], a[156:159], v[76:79], v[140:143]
  ds_read_b64 v[234:235], v89 offset:2048
  buffer_load_dwordx4 v2, s[4:7], s26 offen offset:3072 sc1 lds
  s_add_u32 m0, s16, 12288
  v_mfma_f32_16x16x32_bf16 v[144:147], a[160:163], v[32:35], 0
  v_mfma_f32_16x16x32_bf16 v[148:151], a[160:163], v[36:39], 0
  v_cvt_pk_bf16_f32 v208, v128, v129
  v_cvt_pk_bf16_f32 v209, v130, v131
  ds_write_b64 v84, v[208:209] offset:0
  v_cvt_pk_bf16_f32 v210, v132, v133
  v_cvt_pk_bf16_f32 v211, v134, v135
  ds_write_b64 v84, v[210:211] offset:256
  v_mul_f32 v26, v128, v128
  v_fmac_f32 v26, v129, v129
  v_fmac_f32 v26, v130, v130
  v_fmac_f32 v26, v131, v131
  v_mul_f32 v27, v132, v132
  v_fmac_f32 v27, v133, v133
  v_fmac_f32 v27, v134, v134
  v_fmac_f32 v27, v135, v135
  v_mfma_f32_16x16x32_bf16 v[144:147], a[164:167], v[40:43], v[144:147]
  v_mfma_f32_16x16x32_bf16 v[148:151], a[164:167], v[44:47], v[148:151]
  buffer_load_dwordx4 v2, s[4:7], s27 offen offset:0 sc1 lds
  v_mfma_f32_16x16x32_bf16 v[144:147], a[168:171], v[48:51], v[144:147]
  v_mfma_f32_16x16x32_bf16 v[148:151], a[168:171], v[52:55], v[148:151]
  v_cvt_pk_bf16_f32 v212, v136, v137
  v_cvt_pk_bf16_f32 v213, v138, v139
  ds_write_b64 v84, v[212:213] offset:1024
  v_cvt_pk_bf16_f32 v214, v140, v141
  v_cvt_pk_bf16_f32 v215, v142, v143
  ds_write_b64 v84, v[214:215] offset:1280
  v_fmac_f32 v26, v136, v136
  v_fmac_f32 v26, v137, v137
  v_fmac_f32 v26, v138, v138
  v_fmac_f32 v26, v139, v139
  v_fmac_f32 v27, v140, v140
  v_fmac_f32 v27, v141, v141
  v_fmac_f32 v27, v142, v142
  v_fmac_f32 v27, v143, v143
  v_mfma_f32_16x16x32_bf16 v[144:147], a[172:175], v[56:59], v[144:147]
  v_mfma_f32_16x16x32_bf16 v[148:151], a[172:175], v[60:63], v[148:151]
  buffer_load_dwordx4 v2, s[4:7], s27 offen offset:1024 sc1 lds
  v_mfma_f32_16x16x32_bf16 v[144:147], a[176:179], v[64:67], v[144:147]
  v_mfma_f32_16x16x32_bf16 v[148:151], a[176:179], v[68:71], v[148:151]
  buffer_load_dwordx4 v2, s[4:7], s27 offen offset:2048 sc1 lds
  v_mfma_f32_16x16x32_bf16 v[144:147], a[180:183], v[72:75], v[144:147]
  v_mfma_f32_16x16x32_bf16 v[148:151], a[180:183], v[76:79], v[148:151]
  buffer_load_dwordx4 v2, s[4:7], s27 offen offset:3072 sc1 lds
  s_add_u32 m0, s16, 16384
  s_nop 4
  v_cvt_pk_bf16_f32 v216, v144, v145
  v_cvt_pk_bf16_f32 v217, v146, v147
  ds_write_b64 v84, v[216:217] offset:2048
  v_cvt_pk_bf16_f32 v218, v148, v149
  v_cvt_pk_bf16_f32 v219, v150, v151
  ds_write_b64 v84, v[218:219] offset:2304
  v_fmac_f32 v26, v144, v144
  v_fmac_f32 v26, v145, v145
  v_fmac_f32 v26, v146, v146
  v_fmac_f32 v26, v147, v147
  v_fmac_f32 v27, v148, v148
  v_fmac_f32 v27, v149, v149
  v_fmac_f32 v27, v150, v150
  v_fmac_f32 v27, v151, v151
  v_mov_b32 v28, v26
  v_mov_b32 v29, v27
  s_nop 0
  v_permlane16_swap_b32 v26, v28
  v_permlane16_swap_b32 v27, v29
  v_add_f32 v26, v26, v28
  v_mov_b32 v28, v26
  v_add_f32 v27, v27, v29
  v_mov_b32 v29, v27
  v_permlane32_swap_b32 v26, v28
  s_nop 0
  v_permlane32_swap_b32 v27, v29
  v_add_f32 v26, v26, v28
  ds_write_b32 v87, v26 offset:0
  v_add_f32 v27, v27, v29
  ds_write_b32 v87, v27 offset:256
  s_waitcnt lgkmcnt(0)
  s_barrier
  ds_read_b128 v[192:195], v11
  ds_read_b128 a[0:3], v85 offset:0
  ds_read_b128 a[4:7], v85 offset:1024
  ds_read_b128 a[8:11], v85 offset:2048
  ds_read_b128 a[12:15], v85 offset:40960
  s_waitcnt vmcnt(12)
  ds_read_b128 a[48:51], v3 offset:0
  ds_read_b128 a[52:55], v4 offset:0
  ds_read_b128 a[56:59], v5 offset:0
  ds_read_b128 a[60:63], v6 offset:0
  s_waitcnt vmcnt(8)
  ds_read_b128 a[64:67], v3 offset:4096
  ds_read_b128 a[68:71], v4 offset:4096
  buffer_load_dwordx4 v2, s[4:7], s28 offen offset:0 sc1 lds
  buffer_load_dwordx4 v2, s[4:7], s28 offen offset:1024 sc1 lds
  buffer_load_dwordx4 v2, s[4:7], s28 offen offset:2048 sc1 lds
  s_waitcnt lgkmcnt(10)
  v_add_f32 v192, v192, v193
  v_add_f32 v194, v194, v195
  v_add_f32 v192, v192, v194
  v_sqrt_f32 v192, v192
  v_mov_b32 v193, 0x42a00000
  v_mul_f32 v192, 0x415feb66, v192
  v_cmp_nle_f32 vcc, v192, v193
  v_sub_f32 v160, 0x42800000, v192
  v_sub_f32 v161, 0x42800000, v192
  s_cbranch_vccnz ts_b_fb
  v_pk_mov_b32 v[162:163], v[160:161], v[160:161]
  v_pk_mov_b32 v[164:165], v[160:161], v[160:161]
  v_pk_mov_b32 v[166:167], v[160:161], v[160:161]
  v_pk_mov_b32 v[168:169], v[160:161], v[160:161]
  v_pk_mov_b32 v[170:171], v[160:161], v[160:161]
  v_pk_mov_b32 v[172:173], v[160:161], v[160:161]
  v_pk_mov_b32 v[174:175], v[160:161], v[160:161]
ts_b_go:
  s_waitcnt lgkmcnt(4)
  s_nop 0
  v_mfma_f32_32x32x16_bf16 v[128:143], a[48:51], a[0:3], v[160:175]
  ds_read_b128 a[16:19], v85 offset:41984
  ds_read_b128 a[72:75], v5 offset:4096
  buffer_load_dwordx4 v2, s[4:7], s28 offen offset:3072 sc1 lds
  s_add_u32 m0, s16, 20480
  v_mfma_f32_32x32x16_bf16 v[128:143], a[52:55], a[4:7], v[128:143]
  ds_read_b128 a[20:23], v85 offset:43008
  ds_read_b128 a[76:79], v6 offset:4096
  buffer_load_dwordx4 v2, s[4:7], s29 offen offset:0 sc1 lds
  s_waitcnt lgkmcnt(6)
  v_mfma_f32_32x32x16_bf16 v[128:143], a[56:59], a[8:11], v[128:143]
  ds_read_b128 a[24:27], v86 offset:0
  s_waitcnt vmcnt(9)
  ds_read_b128 a[48:51], v3 offset:8192
  buffer_load_dwordx4 v2, s[4:7], s29 offen offset:1024 sc1 lds
  v_mfma_f32_32x32x16_bf16 v[128:143], a[60:63], a[12:15], v[128:143]
  ds_read_b128 a[28:31], v86 offset:1024
  ds_read_b128 a[52:55], v4 offset:8192
  buffer_load_dwordx4 v2, s[4:7], s29 offen offset:2048 sc1 lds
  s_waitcnt lgkmcnt(8)
  s_waitcnt lgkmcnt(7)
  v_mfma_f32_32x32x16_bf16 v[128:143], a[64:67], a[16:19], v[128:143]
  ds_read_b128 a[32:35], v86 offset:2048
  ds_read_b128 a[56:59], v5 offset:8192
  buffer_load_dwordx4 v2, s[4:7], s29 offen offset:3072 sc1 lds
  s_add_u32 m0, s16, 24576
  s_waitcnt lgkmcnt(7)
  v_mfma_f32_32x32x16_bf16 v[128:143], a[68:71], a[20:23], v[128:143]
  ds_read_b128 a[36:39], v86 offset:40960
  ds_read_b128 a[60:63], v6 offset:8192
  s_waitcnt lgkmcnt(8)
  s_waitcnt lgkmcnt(7)
  v_mfma_f32_32x32x16_bf16 v[128:143], a[72:75], a[24:27], v[128:143]
  ds_read_b128 a[40:43], v86 offset:41984
  s_waitcnt vmcnt(8)
  ds_read_b128 a[64:67], v3 offset:12288
  buffer_load_dwordx4 v2, s[4:7], s30 offen offset:0 sc1 lds
  s_waitcnt lgkmcnt(7)
  v_mfma_f32_32x32x16_bf16 v[128:143], a[76:79], a[28:31], v[128:143]
  ds_read_b128 a[44:47], v86 offset:43008
  ds_read_b128 a[68:71], v4 offset:12288
  s_waitcnt lgkmcnt(8)
  s_waitcnt lgkmcnt(7)
  v_mfma_f32_32x32x16_bf16 v[128:143], a[48:51], a[32:35], v[128:143]
  ds_read_b128 a[72:75], v5 offset:12288
  buffer_load_dwordx4 v2, s[4:7], s30 offen offset:1024 sc1 lds
  s_waitcnt lgkmcnt(6)
  v_mfma_f32_32x32x16_bf16 v[128:143], a[52:55], a[36:39], v[128:143]
  ds_read_b128 a[76:79], v6 offset:12288
  s_waitcnt lgkmcnt(6)
  s_waitcnt lgkmcnt(5)
  v_mfma_f32_32x32x16_bf16 v[128:143], a[56:59], a[40:43], v[128:143]
  s_waitcnt vmcnt(6)
  ds_read_b128 a[48:51], v3 offset:16384
  buffer_load_dwordx4 v2, s[4:7], s30 offen offset:2048 sc1 lds
  s_waitcnt lgkmcnt(4)
  v_mfma_f32_32x32x16_bf16 v[128:143], a[60:63], a[44:47], v[128:143]
  ds_read_b128 a[52:55], v4 offset:16384
  s_waitcnt lgkmcnt(4)
  v_mfma_f32_32x32x16_bf16 v[144:159], a[64:67], a[0:3], v[160:175]
  s_barrier
  ds_read_b128 a[56:59], v5 offset:16384
  buffer_load_dwordx4 v2, s[4:7], s30 offen offset:3072 sc1 lds
  s_add_u32 m0, s16, 28672
  v_mfma_f32_32x32x16_bf16 v[144:159], a[68:71], a[4:7], v[144:159]
  ds_read_b128 a[60:63], v6 offset:16384
  buffer_load_dwordx4 v2, s[4:7], s31 offen offset:0 sc1 lds
  s_waitcnt lgkmcnt(4)
  v_mfma_f32_32x32x16_bf16 v[144:159], a[72:75], a[8:11], v[144:159]
  s_waitcnt vmcnt(5)
  ds_read_b128 a[64:67], v3 offset:20480
  buffer_load_dwordx4 v2, s[4:7], s31 offen offset:1024 sc1 lds
  v_exp_f32 v128, v128
  v_exp_f32 v129, v129
  v_mfma_f32_32x32x16_bf16 v[144:159], a[76:79], a[12:15], v[144:159]
  ds_read_b128 a[68:71], v4 offset:20480
  buffer_load_dwordx4 v2, s[4:7], s31 offen offset:2048 sc1 lds
  v_exp_f32 v130, v130
  v_cvt_pk_bf16_f32 v176, v128, v129
  v_add_f32 v22, v22, v128
  s_waitcnt lgkmcnt(4)
  v_mfma_f32_32x32x16_bf16 v[144:159], a[48:51], a[16:19], v[144:159]
  ds_read_b128 a[72:75], v5 offset:20480
  buffer_load_dwordx4 v2, s[4:7], s31 offen offset:3072 sc1 lds
  s_add_u32 m0, s16, 32768
  v_exp_f32 v131, v131
  v_add_f32 v23, v23, v129
  v_exp_f32 v132, v132
  v_mfma_f32_32x32x16_bf16 v[144:159], a[52:55], a[20:23], v[144:159]
  ds_read_b128 a[76:79], v6 offset:20480
  buffer_load_dwordx4 v2, s[4:7], s32 offen offset:0 sc1 lds
  v_cvt_pk_bf16_f32 v177, v130, v131
  v_add_f32 v22, v22, v130
  v_exp_f32 v133, v133
  v_add_f32 v23, v23, v131
  s_waitcnt lgkmcnt(4)
  v_mfma_f32_32x32x16_bf16 v[144:159], a[56:59], a[24:27], v[144:159]
  buffer_load_dwordx4 v2, s[4:7], s32 offen offset:1024 sc1 lds
  v_exp_f32 v134, v134
  v_cvt_pk_bf16_f32 v178, v132, v133
  v_add_f32 v22, v22, v132
  v_exp_f32 v135, v135
  v_add_f32 v23, v23, v133
  v_mfma_f32_32x32x16_bf16 v[144:159], a[60:63], a[28:31], v[144:159]
  ds_read_b64_tr_b16 a[80:81], v7 offset:0
  ds_read_b64_tr_b16 a[82:83], v8 offset:0
  buffer_load_dwordx4 v2, s[4:7], s32 offen offset:2048 sc1 lds
  v_exp_f32 v136, v136
  v_cvt_pk_bf16_f32 v179, v134, v135
  v_add_f32 v22, v22, v134
  s_waitcnt lgkmcnt(4)
  v_mfma_f32_32x32x16_bf16 v[144:159], a[64:67], a[32:35], v[144:159]
  ds_read_b64_tr_b16 a[84:85], v9 offset:0
  ds_read_b64_tr_b16 a[86:87], v10 offset:0
  buffer_load_dwordx4 v2, s[4:7], s32 offen offset:3072 sc1 lds
  s_add_u32 m0, s16, 36864
  v_exp_f32 v137, v137
  v_add_f32 v23, v23, v135
  v_mfma_f32_32x32x16_bf16 v[144:159], a[68:71], a[36:39], v[144:159]
  ds_read_b64_tr_b16 a[88:89], v7 offset:2048
  ds_read_b64_tr_b16 a[90:91], v8 offset:2048
  v_exp_f32 v138, v138
  v_cvt_pk_bf16_f32 v180, v136, v137
  v_add_f32 v22, v22, v136
  s_waitcnt lgkmcnt(6)
  v_mfma_f32_32x32x16_bf16 v[144:159], a[72:75], a[40:43], v[144:159]
  ds_read_b64_tr_b16 a[92:93], v9 offset:2048
  ds_read_b64_tr_b16 a[94:95], v10 offset:2048
  buffer_load_dwordx4 v2, s[4:7], s33 offen offset:0 sc1 lds
  v_exp_f32 v139, v139
  v_add_f32 v23, v23, v137
  v_exp_f32 v140, v140
  v_mfma_f32_32x32x16_bf16 v[144:159], a[76:79], a[44:47], v[144:159]
  ds_read_b64_tr_b16 a[96:97], v7 offset:4096
  ds_read_b64_tr_b16 a[98:99], v8 offset:4096
  v_cvt_pk_bf16_f32 v181, v138, v139
  v_add_f32 v22, v22, v138
  v_exp_f32 v141, v141
  v_add_f32 v23, v23, v139
  ds_read_b64_tr_b16 a[100:101], v9 offset:4096
  ds_read_b64_tr_b16 a[102:103], v10 offset:4096
  buffer_load_dwordx4 v2, s[4:7], s33 offen offset:1024 sc1 lds
  v_exp_f32 v142, v142
  v_cvt_pk_bf16_f32 v182, v140, v141
  v_add_f32 v22, v22, v140
  s_waitcnt lgkmcnt(8)
  v_mfma_f32_32x32x16_bf16 v[32:47], a[80:83], v[176:179], 0
  ds_read_b64_tr_b16 a[104:105], v7 offset:6144
  ds_read_b64_tr_b16 a[106:107], v8 offset:6144
  buffer_load_dwordx4 v2, s[4:7], s33 offen offset:2048 sc1 lds
  v_exp_f32 v143, v143
  v_add_f32 v23, v23, v141
  v_cvt_pk_bf16_f32 v183, v142, v143
  v_add_f32 v22, v22, v142
  v_mfma_f32_32x32x16_bf16 v[48:63], a[84:87], v[176:179], 0
  ds_read_b64_tr_b16 a[108:109], v9 offset:6144
  ds_read_b64_tr_b16 a[110:111], v10 offset:6144
  v_add_f32 v23, v23, v143
  v_exp_f32 v144, v144
  s_waitcnt lgkmcnt(8)
  v_mfma_f32_32x32x16_bf16 v[32:47], a[88:91], v[180:183], v[32:47]
  ds_read_b64_tr_b16 a[80:81], v7 offset:8192
  ds_read_b64_tr_b16 a[82:83], v8 offset:8192
  buffer_load_dwordx4 v2, s[4:7], s33 offen offset:3072 sc1 lds
  s_add_u32 m0, s16, 0
  v_exp_f32 v145, v145
  v_mfma_f32_32x32x16_bf16 v[48:63], a[92:95], v[180:183], v[48:63]
  ds_read_b64_tr_b16 a[84:85], v9 offset:8192
  ds_read_b64_tr_b16 a[86:87], v10 offset:8192
  v_exp_f32 v146, v146
  v_cvt_pk_bf16_f32 v184, v144, v145
  s_waitcnt lgkmcnt(8)
  v_mfma_f32_32x32x16_bf16 v[64:79], a[96:99], v[176:179], 0
  ds_read_b64_tr_b16 a[88:89], v7 offset:10240
  ds_read_b64_tr_b16 a[90:91], v8 offset:10240
  buffer_load_dwordx4 v2, s[4:7], s34 offen offset:0 sc1 lds
  v_add_f32 v22, v22, v144
  v_exp_f32 v147, v147
  v_mfma_f32_32x32x16_bf16 v[80:95], a[100:103], v[176:179], 0
  ds_read_b64_tr_b16 a[92:93], v9 offset:10240
  ds_read_b64_tr_b16 a[94:95], v10 offset:10240
  v_add_f32 v23, v23, v145
  v_exp_f32 v148, v148
  s_waitcnt lgkmcnt(8)
  v_mfma_f32_32x32x16_bf16 v[64:79], a[104:107], v[180:183], v[64:79]
  s_waitcnt vmcnt(13)
  ds_read_b128 a[48:51], v3 offset:24576
  buffer_load_dwordx4 v2, s[4:7], s34 offen offset:1024 sc1 lds
  v_cvt_pk_bf16_f32 v185, v146, v147
  v_add_f32 v22, v22, v146
  v_mfma_f32_32x32x16_bf16 v[80:95], a[108:111], v[180:183], v[80:95]
  ds_read_b128 a[52:55], v4 offset:24576
  v_exp_f32 v149, v149
  v_add_f32 v23, v23, v147
  s_waitcnt lgkmcnt(6)
  v_mfma_f32_32x32x16_bf16 v[96:111], a[80:83], v[176:179], 0
  ds_read_b128 a[56:59], v5 offset:24576
  buffer_load_dwordx4 v2, s[4:7], s34 offen offset:2048 sc1 lds
  v_exp_f32 v150, v150
  v_cvt_pk_bf16_f32 v186, v148, v149
  v_add_f32 v22, v22, v148
  v_mfma_f32_32x32x16_bf16 v[112:127], a[84:87], v[176:179], 0
  ds_read_b128 a[60:63], v6 offset:24576
  v_exp_f32 v151, v151
  v_add_f32 v23, v23, v149
  s_waitcnt lgkmcnt(4)
  v_mfma_f32_32x32x16_bf16 v[96:111], a[88:91], v[180:183], v[96:111]
  s_waitcnt vmcnt(11)
  ds_read_b128 a[64:67], v3 offset:28672
  buffer_load_dwordx4 v2, s[4:7], s34 offen offset:3072 sc1 lds
  s_add_u32 m0, s16, 4096
  v_exp_f32 v152, v152
  v_mfma_f32_32x32x16_bf16 v[112:127], a[92:95], v[180:183], v[112:127]
  ds_read_b128 a[68:71], v4 offset:28672
  v_cvt_pk_bf16_f32 v187, v150, v151
  v_add_f32 v22, v22, v150
  v_exp_f32 v153, v153
  s_waitcnt lgkmcnt(4)
  v_mfma_f32_32x32x16_bf16 v[128:143], a[48:51], a[0:3], v[160:175]
  ds_read_b128 a[72:75], v5 offset:28672
  buffer_load_dwordx4 v2, s[4:7], s35 offen offset:0 sc1 lds
  v_add_f32 v23, v23, v151
  v_exp_f32 v154, v154
  v_cvt_pk_bf16_f32 v188, v152, v153
  v_mfma_f32_32x32x16_bf16 v[128:143], a[52:55], a[4:7], v[128:143]
  ds_read_b128 a[76:79], v6 offset:28672
  v_add_f32 v22, v22, v152
  v_exp_f32 v155, v155
  v_add_f32 v23, v23, v153
  s_waitcnt lgkmcnt(4)
  v_mfma_f32_32x32x16_bf16 v[128:143], a[56:59], a[8:11], v[128:143]
  s_waitcnt vmcnt(9)
  ds_read_b128 a[48:51], v3 offset:32768
  buffer_load_dwordx4 v2, s[4:7], s35 offen offset:1024 sc1 lds
  v_exp_f32 v156, v156
  v_cvt_pk_bf16_f32 v189, v154, v155
  v_mfma_f32_32x32x16_bf16 v[128:143], a[60:63], a[12:15], v[128:143]
  ds_read_b128 a[52:55], v4 offset:32768
  v_add_f32 v22, v22, v154
  v_exp_f32 v157, v157
  v_add_f32 v23, v23, v155
  s_waitcnt lgkmcnt(4)
  v_mfma_f32_32x32x16_bf16 v[128:143], a[64:67], a[16:19], v[128:143]
  ds_read_b128 a[56:59], v5 offset:32768
  buffer_load_dwordx4 v2, s[4:7], s35 offen offset:2048 sc1 lds
  v_exp_f32 v158, v158
  v_cvt_pk_bf16_f32 v190, v156, v157
  v_add_f32 v22, v22, v156
  v_mfma_f32_32x32x16_bf16 v[128:143], a[68:71], a[20:23], v[128:143]
  ds_read_b128 a[60:63], v6 offset:32768
  v_exp_f32 v159, v159
  v_add_f32 v23, v23, v157
  v_cvt_pk_bf16_f32 v191, v158, v159
  s_waitcnt lgkmcnt(4)
  v_mfma_f32_32x32x16_bf16 v[128:143], a[72:75], a[24:27], v[128:143]
  ds_read_b64_tr_b16 a[96:97], v7 offset:12288
  ds_read_b64_tr_b16 a[98:99], v8 offset:12288
  buffer_load_dwordx4 v2, s[4:7], s35 offen offset:3072 sc1 lds
  s_add_u32 m0, s16, 8192
  v_add_f32 v22, v22, v158
  v_add_f32 v23, v23, v159
  v_mfma_f32_32x32x16_bf16 v[128:143], a[76:79], a[28:31], v[128:143]
  ds_read_b64_tr_b16 a[100:101], v9 offset:12288
  ds_read_b64_tr_b16 a[102:103], v10 offset:12288
  s_waitcnt lgkmcnt(6)
  v_mfma_f32_32x32x16_bf16 v[128:143], a[48:51], a[32:35], v[128:143]
  ds_read_b64_tr_b16 a[104:105], v7 offset:14336
  ds_read_b64_tr_b16 a[106:107], v8 offset:14336
  buffer_load_dwordx4 v2, s[4:7], s36 offen offset:0 sc1 lds
  v_mfma_f32_32x32x16_bf16 v[128:143], a[52:55], a[36:39], v[128:143]
  ds_read_b64_tr_b16 a[108:109], v9 offset:14336
  ds_read_b64_tr_b16 a[110:111], v10 offset:14336
  s_waitcnt lgkmcnt(8)
  v_mfma_f32_32x32x16_bf16 v[128:143], a[56:59], a[40:43], v[128:143]
  ds_read_b64_tr_b16 a[80:81], v7 offset:16384
  ds_read_b64_tr_b16 a[82:83], v8 offset:16384
  buffer_load_dwordx4 v2, s[4:7], s36 offen offset:1024 sc1 lds
  v_mfma_f32_32x32x16_bf16 v[128:143], a[60:63], a[44:47], v[128:143]
  ds_read_b64_tr_b16 a[84:85], v9 offset:16384
  ds_read_b64_tr_b16 a[86:87], v10 offset:16384
  s_waitcnt lgkmcnt(8)
  v_mfma_f32_32x32x16_bf16 v[32:47], a[96:99], v[184:187], v[32:47]
  ds_read_b64_tr_b16 a[88:89], v7 offset:18432
  ds_read_b64_tr_b16 a[90:91], v8 offset:18432
  buffer_load_dwordx4 v2, s[4:7], s36 offen offset:2048 sc1 lds
  v_mfma_f32_32x32x16_bf16 v[48:63], a[100:103], v[184:187], v[48:63]
  ds_read_b64_tr_b16 a[92:93], v9 offset:18432
  ds_read_b64_tr_b16 a[94:95], v10 offset:18432
  s_waitcnt lgkmcnt(8)
  v_mfma_f32_32x32x16_bf16 v[32:47], a[104:107], v[188:191], v[32:47]
  ds_read_b64_tr_b16 a[96:97], v7 offset:20480
  ds_read_b64_tr_b16 a[98:99], v8 offset:20480
  buffer_load_dwordx4 v2, s[4:7], s36 offen offset:3072 sc1 lds
  s_add_u32 m0, s16, 12288
  v_exp_f32 v128, v128
  v_mfma_f32_32x32x16_bf16 v[48:63], a[108:111], v[188:191], v[48:63]
  ds_read_b64_tr_b16 a[100:101], v9 offset:20480
  ds_read_b64_tr_b16 a[102:103], v10 offset:20480
  v_exp_f32 v129, v129
  s_waitcnt lgkmcnt(8)
  v_mfma_f32_32x32x16_bf16 v[64:79], a[80:83], v[184:187], v[64:79]
  ds_read_b64_tr_b16 a[104:105], v7 offset:22528
  ds_read_b64_tr_b16 a[106:107], v8 offset:22528
  buffer_load_dwordx4 v2, s[4:7], s37 offen offset:0 sc1 lds
  v_exp_f32 v130, v130
  v_cvt_pk_bf16_f32 v176, v128, v129
  v_mfma_f32_32x32x16_bf16 v[80:95], a[84:87], v[184:187], v[80:95]
  ds_read_b64_tr_b16 a[108:109], v9 offset:22528
  ds_read_b64_tr_b16 a[110:111], v10 offset:22528
  v_add_f32 v22, v22, v128
  v_exp_f32 v131, v131
  s_waitcnt lgkmcnt(8)
  v_mfma_f32_32x32x16_bf16 v[64:79], a[88:91], v[188:191], v[64:79]
  s_waitcnt vmcnt(13)
  ds_read_b128 a[64:67], v3 offset:36864
  buffer_load_dwordx4 v2, s[4:7], s37 offen offset:1024 sc1 lds
  v_add_f32 v23, v23, v129
  v_exp_f32 v132, v132
  v_mfma_f32_32x32x16_bf16 v[80:95], a[92:95], v[188:191], v[80:95]
  ds_read_b128 a[68:71], v4 offset:36864
  v_cvt_pk_bf16_f32 v177, v130, v131
  v_add_f32 v22, v22, v130
  v_exp_f32 v133, v133
  s_waitcnt lgkmcnt(6)
  v_mfma_f32_32x32x16_bf16 v[96:111], a[96:99], v[184:187], v[96:111]
  ds_read_b128 a[72:75], v5 offset:36864
  buffer_load_dwordx4 v2, s[4:7], s37 offen offset:2048 sc1 lds
  v_add_f32 v23, v23, v131
  v_exp_f32 v134, v134
  v_cvt_pk_bf16_f32 v178, v132, v133
  v_mfma_f32_32x32x16_bf16 v[112:127], a[100:103], v[184:187], v[112:127]
  ds_read_b128 a[76:79], v6 offset:36864
  v_add_f32 v22, v22, v132
  v_exp_f32 v135, v135
  v_add_f32 v23, v23, v133
  s_waitcnt lgkmcnt(4)
  v_mfma_f32_32x32x16_bf16 v[96:111], a[104:107], v[188:191], v[96:111]
  s_waitcnt vmcnt(11)
  ds_read_b128 a[48:51], v3 offset:0
  buffer_load_dwordx4 v2, s[4:7], s37 offen offset:3072 sc1 lds
  s_add_u32 m0, s16, 16384
  v_exp_f32 v136, v136
  v_mfma_f32_32x32x16_bf16 v[112:127], a[108:111], v[188:191], v[112:127]
  ds_read_b128 a[52:55], v4 offset:0
  v_cvt_pk_bf16_f32 v179, v134, v135
  v_add_f32 v22, v22, v134
  v_exp_f32 v137, v137
  s_waitcnt lgkmcnt(4)
  v_mfma_f32_32x32x16_bf16 v[144:159], a[64:67], a[0:3], v[160:175]
  ds_read_b128 a[56:59], v5 offset:0
  buffer_load_dwordx4 v2, s[4:7], s38 offen offset:0 sc1 lds
  v_add_f32 v23, v23, v135
  v_exp_f32 v138, v138
  v_cvt_pk_bf16_f32 v180, v136, v137
  v_mfma_f32_32x32x16_bf16 v[144:159], a[68:71], a[4:7], v[144:159]
  ds_read_b128 a[60:63], v6 offset:0
  v_add_f32 v22, v22, v136
  v_exp_f32 v139, v139
  v_add_f32 v23, v23, v137
  s_waitcnt lgkmcnt(4)
  v_mfma_f32_32x32x16_bf16 v[144:159], a[72:75], a[8:11], v[144:159]
  s_waitcnt vmcnt(9)
  ds_read_b128 a[64:67], v3 offset:4096
  buffer_load_dwordx4 v2, s[4:7], s38 offen offset:1024 sc1 lds
  v_exp_f32 v140, v140
  v_cvt_pk_bf16_f32 v181, v138, v139
  v_mfma_f32_32x32x16_bf16 v[144:159], a[76:79], a[12:15], v[144:159]
  ds_read_b128 a[68:71], v4 offset:4096
  v_add_f32 v22, v22, v138
  v_exp_f32 v141, v141
  v_add_f32 v23, v23, v139
  s_waitcnt lgkmcnt(4)
  v_mfma_f32_32x32x16_bf16 v[144:159], a[48:51], a[16:19], v[144:159]
  ds_read_b128 a[72:75], v5 offset:4096
  buffer_load_dwordx4 v2, s[4:7], s38 offen offset:2048 sc1 lds
  v_exp_f32 v142, v142
  v_cvt_pk_bf16_f32 v182, v140, v141
  v_add_f32 v22, v22, v140
  v_mfma_f32_32x32x16_bf16 v[144:159], a[52:55], a[20:23], v[144:159]
  ds_read_b128 a[76:79], v6 offset:4096
  v_exp_f32 v143, v143
  v_add_f32 v23, v23, v141
  v_cvt_pk_bf16_f32 v183, v142, v143
  s_waitcnt lgkmcnt(4)
  v_mfma_f32_32x32x16_bf16 v[144:159], a[56:59], a[24:27], v[144:159]
  ds_read_b64_tr_b16 a[80:81], v7 offset:24576
  ds_read_b64_tr_b16 a[82:83], v8 offset:24576
  buffer_load_dwordx4 v2, s[4:7], s38 offen offset:3072 sc1 lds
  s_add_u32 m0, s16, 20480
  v_add_f32 v22, v22, v142
  v_add_f32 v23, v23, v143
  v_mfma_f32_32x32x16_bf16 v[144:159], a[60:63], a[28:31], v[144:159]
  ds_read_b64_tr_b16 a[84:85], v9 offset:24576
  ds_read_b64_tr_b16 a[86:87], v10 offset:24576
  s_waitcnt lgkmcnt(6)
  v_mfma_f32_32x32x16_bf16 v[144:159], a[64:67], a[32:35], v[144:159]
  ds_read_b64_tr_b16 a[88:89], v7 offset:26624
  ds_read_b64_tr_b16 a[90:91], v8 offset:26624
  buffer_load_dwordx4 v2, s[4:7], s39 offen offset:0 sc1 lds
  v_mfma_f32_32x32x16_bf16 v[144:159], a[68:71], a[36:39], v[144:159]
  ds_read_b64_tr_b16 a[92:93], v9 offset:26624
  ds_read_b64_tr_b16 a[94:95], v10 offset:26624
  buffer_load_dword v31, v21, s[4:7], 0 offen sc1
  s_waitcnt lgkmcnt(8)
  v_mfma_f32_32x32x16_bf16 v[144:159], a[72:75], a[40:43], v[144:159]
  ds_read_b64_tr_b16 a[96:97], v7 offset:28672
  ds_read_b64_tr_b16 a[98:99], v8 offset:28672
  buffer_load_dwordx4 v2, s[4:7], s39 offen offset:1024 sc1 lds
  v_mfma_f32_32x32x16_bf16 v[144:159], a[76:79], a[44:47], v[144:159]
  ds_read_b64_tr_b16 a[100:101], v9 offset:28672
  ds_read_b64_tr_b16 a[102:103], v10 offset:28672
  s_waitcnt lgkmcnt(8)
  v_mfma_f32_32x32x16_bf16 v[32:47], a[80:83], v[176:179], v[32:47]
  ds_read_b64_tr_b16 a[104:105], v7 offset:30720
  ds_read_b64_tr_b16 a[106:107], v8 offset:30720
  buffer_load_dwordx4 v2, s[4:7], s39 offen offset:2048 sc1 lds
  v_mfma_f32_32x32x16_bf16 v[48:63], a[84:87], v[176:179], v[48:63]
  ds_read_b64_tr_b16 a[108:109], v9 offset:30720
  ds_read_b64_tr_b16 a[110:111], v10 offset:30720
  s_waitcnt lgkmcnt(8)
  v_mfma_f32_32x32x16_bf16 v[32:47], a[88:91], v[180:183], v[32:47]
  ds_read_b64_tr_b16 a[80:81], v7 offset:32768
  ds_read_b64_tr_b16 a[82:83], v8 offset:32768
  buffer_load_dwordx4 v2, s[4:7], s39 offen offset:3072 sc1 lds
  s_add_u32 m0, s16, 24576
  v_exp_f32 v144, v144
  v_mfma_f32_32x32x16_bf16 v[48:63], a[92:95], v[180:183], v[48:63]
  ds_read_b64_tr_b16 a[84:85], v9 offset:32768
  ds_read_b64_tr_b16 a[86:87], v10 offset:32768
  v_exp_f32 v145, v145
  s_waitcnt lgkmcnt(8)
  v_mfma_f32_32x32x16_bf16 v[64:79], a[96:99], v[176:179], v[64:79]
  ds_read_b64_tr_b16 a[88:89], v7 offset:34816
  ds_read_b64_tr_b16 a[90:91], v8 offset:34816
  buffer_load_dwordx4 v2, s[4:7], s40 offen offset:0 sc1 lds
  v_exp_f32 v146, v146
  v_cvt_pk_bf16_f32 v184, v144, v145
  v_mfma_f32_32x32x16_bf16 v[80:95], a[100:103], v[176:179], v[80:95]
  ds_read_b64_tr_b16 a[92:93], v9 offset:34816
  ds_read_b64_tr_b16 a[94:95], v10 offset:34816
  v_add_f32 v22, v22, v144
  v_exp_f32 v147, v147
  s_waitcnt lgkmcnt(8)
  v_mfma_f32_32x32x16_bf16 v[64:79], a[104:107], v[180:183], v[64:79]
  s_waitcnt vmcnt(14)
  ds_read_b128 a[48:51], v3 offset:8192
  buffer_load_dwordx4 v2, s[4:7], s40 offen offset:1024 sc1 lds
  v_add_f32 v23, v23, v145
  v_exp_f32 v148, v148
  v_mfma_f32_32x32x16_bf16 v[80:95], a[108:111], v[180:183], v[80:95]
  ds_read_b128 a[52:55], v4 offset:8192
  v_cvt_pk_bf16_f32 v185, v146, v147
  v_add_f32 v22, v22, v146
  v_exp_f32 v149, v149
  s_waitcnt lgkmcnt(6)
  v_mfma_f32_32x32x16_bf16 v[96:111], a[80:83], v[176:179], v[96:111]
  ds_read_b128 a[56:59], v5 offset:8192
  buffer_load_dwordx4 v2, s[4:7], s40 offen offset:2048 sc1 lds
  v_add_f32 v23, v23, v147
  v_exp_f32 v150, v150
  v_cvt_pk_bf16_f32 v186, v148, v149
  v_mfma_f32_32x32x16_bf16 v[112:127], a[84:87], v[176:179], v[112:127]
  ds_read_b128 a[60:63], v6 offset:8192
  v_add_f32 v22, v22, v148
  v_exp_f32 v151, v151
  v_add_f32 v23, v23, v149
  s_waitcnt lgkmcnt(4)
  v_mfma_f32_32x32x16_bf16 v[96:111], a[88:91], v[180:183], v[96:111]
  s_waitcnt vmcnt(12)
  ds_read_b128 a[64:67], v3 offset:12288
  buffer_load_dwordx4 v2, s[4:7], s40 offen offset:3072 sc1 lds
  s_add_u32 m0, s16, 28672
  v_exp_f32 v152, v152
  v_mfma_f32_32x32x16_bf16 v[112:127], a[92:95], v[180:183], v[112:127]
  ds_read_b128 a[68:71], v4 offset:12288
  v_cvt_pk_bf16_f32 v187, v150, v151
  v_add_f32 v22, v22, v150
  v_exp_f32 v153, v153
  s_waitcnt lgkmcnt(4)
  v_mfma_f32_32x32x16_bf16 v[128:143], a[48:51], a[0:3], v[160:175]
  ds_read_b128 a[72:75], v5 offset:12288
  buffer_load_dwordx4 v2, s[4:7], s41 offen offset:0 sc1 lds
  v_add_f32 v23, v23, v151
  v_exp_f32 v154, v154
  v_cvt_pk_bf16_f32 v188, v152, v153
  v_mfma_f32_32x32x16_bf16 v[128:143], a[52:55], a[4:7], v[128:143]
  ds_read_b128 a[76:79], v6 offset:12288
  v_add_f32 v22, v22, v152
  v_exp_f32 v155, v155
  v_add_f32 v23, v23, v153
  s_waitcnt lgkmcnt(4)
  v_mfma_f32_32x32x16_bf16 v[128:143], a[56:59], a[8:11], v[128:143]
  s_waitcnt vmcnt(10)
  ds_read_b128 a[48:51], v3 offset:16384
  buffer_load_dwordx4 v2, s[4:7], s41 offen offset:1024 sc1 lds
  v_exp_f32 v156, v156
  v_cvt_pk_bf16_f32 v189, v154, v155
  v_mfma_f32_32x32x16_bf16 v[128:143], a[60:63], a[12:15], v[128:143]
  ds_read_b128 a[52:55], v4 offset:16384
  v_add_f32 v22, v22, v154
  v_exp_f32 v157, v157
  v_add_f32 v23, v23, v155
  s_waitcnt lgkmcnt(4)
  v_mfma_f32_32x32x16_bf16 v[128:143], a[64:67], a[16:19], v[128:143]
  ds_read_b128 a[56:59], v5 offset:16384
  buffer_load_dwordx4 v2, s[4:7], s41 offen offset:2048 sc1 lds
  v_exp_f32 v158, v158
  v_cvt_pk_bf16_f32 v190, v156, v157
  v_add_f32 v22, v22, v156
  v_mfma_f32_32x32x16_bf16 v[128:143], a[68:71], a[20:23], v[128:143]
  ds_read_b128 a[60:63], v6 offset:16384
  v_exp_f32 v159, v159
  v_add_f32 v23, v23, v157
  v_cvt_pk_bf16_f32 v191, v158, v159
  s_waitcnt lgkmcnt(4)
  v_mfma_f32_32x32x16_bf16 v[128:143], a[72:75], a[24:27], v[128:143]
  ds_read_b64_tr_b16 a[96:97], v7 offset:36864
  ds_read_b64_tr_b16 a[98:99], v8 offset:36864
  buffer_load_dwordx4 v2, s[4:7], s41 offen offset:3072 sc1 lds
  s_add_u32 m0, s16, 32768
  v_add_f32 v22, v22, v158
  v_add_f32 v23, v23, v159
  v_mfma_f32_32x32x16_bf16 v[128:143], a[76:79], a[28:31], v[128:143]
  ds_read_b64_tr_b16 a[100:101], v9 offset:36864
  ds_read_b64_tr_b16 a[102:103], v10 offset:36864
  s_waitcnt lgkmcnt(6)
  v_mfma_f32_32x32x16_bf16 v[128:143], a[48:51], a[32:35], v[128:143]
  ds_read_b64_tr_b16 a[104:105], v7 offset:38912
  ds_read_b64_tr_b16 a[106:107], v8 offset:38912
  buffer_load_dwordx4 v2, s[4:7], s42 offen offset:0 sc1 lds
  v_mfma_f32_32x32x16_bf16 v[128:143], a[52:55], a[36:39], v[128:143]
  ds_read_b64_tr_b16 a[108:109], v9 offset:38912
  ds_read_b64_tr_b16 a[110:111], v10 offset:38912
  s_waitcnt lgkmcnt(8)
  v_mfma_f32_32x32x16_bf16 v[128:143], a[56:59], a[40:43], v[128:143]
  ds_read_b64_tr_b16 a[80:81], v7 offset:0
  ds_read_b64_tr_b16 a[82:83], v8 offset:0
  buffer_load_dwordx4 v2, s[4:7], s42 offen offset:1024 sc1 lds
  v_mfma_f32_32x32x16_bf16 v[128:143], a[60:63], a[44:47], v[128:143]
  ds_read_b64_tr_b16 a[84:85], v9 offset:0
  ds_read_b64_tr_b16 a[86:87], v10 offset:0
  s_waitcnt lgkmcnt(8)
  v_mfma_f32_32x32x16_bf16 v[32:47], a[96:99], v[184:187], v[32:47]
  ds_read_b64_tr_b16 a[88:89], v7 offset:2048
  ds_read_b64_tr_b16 a[90:91], v8 offset:2048
  s_waitcnt vmcnt(13)
  v_cmp_ne_u32 vcc, s98, v31
  buffer_load_dwordx4 v2, s[4:7], s42 offen offset:2048 sc1 lds
  v_mfma_f32_32x32x16_bf16 v[48:63], a[100:103], v[184:187], v[48:63]
  ds_read_b64_tr_b16 a[92:93], v9 offset:2048
  ds_read_b64_tr_b16 a[94:95], v10 offset:2048
  s_waitcnt lgkmcnt(8)
  v_mfma_f32_32x32x16_bf16 v[32:47], a[104:107], v[188:191], v[32:47]
  s_cbranch_vccnz ts_b_wsl
ts_b_wbk:
  ds_read_b64_tr_b16 a[96:97], v7 offset:4096
  ds_read_b64_tr_b16 a[98:99], v8 offset:4096
  buffer_load_dwordx4 v2, s[4:7], s42 offen offset:3072 sc1 lds
  s_add_u32 m0, s16, 36864
  v_mfma_f32_32x32x16_bf16 v[48:63], a[108:111], v[188:191], v[48:63]
  ds_read_b64_tr_b16 a[100:101], v9 offset:4096
  ds_read_b64_tr_b16 a[102:103], v10 offset:4096
  v_exp_f32 v128, v128
  s_waitcnt lgkmcnt(8)
  v_mfma_f32_32x32x16_bf16 v[64:79], a[80:83], v[184:187], v[64:79]
  ds_read_b64_tr_b16 a[104:105], v7 offset:6144
  ds_read_b64_tr_b16 a[106:107], v8 offset:6144
  buffer_load_dwordx4 v2, s[4:7], s43 offen offset:0 sc1 lds
  v_exp_f32 v129, v129
  v_mfma_f32_32x32x16_bf16 v[80:95], a[84:87], v[184:187], v[80:95]
  ds_read_b64_tr_b16 a[108:109], v9 offset:6144
  ds_read_b64_tr_b16 a[110:111], v10 offset:6144
  v_exp_f32 v130, v130
  v_cvt_pk_bf16_f32 v176, v128, v129
  s_waitcnt lgkmcnt(8)
  v_mfma_f32_32x32x16_bf16 v[64:79], a[88:91], v[188:191], v[64:79]
  s_waitcnt vmcnt(13)
  ds_read_b128 a[64:67], v3 offset:20480
  buffer_load_dwordx4 v2, s[4:7], s43 offen offset:1024 sc1 lds
  v_add_f32 v22, v22, v128
  v_exp_f32 v131, v131
  v_mfma_f32_32x32x16_bf16 v[80:95], a[92:95], v[188:191], v[80:95]
  ds_read_b128 a[68:71], v4 offset:20480
  v_add_f32 v23, v23, v129
  v_exp_f32 v132, v132
  v_cvt_pk_bf16_f32 v177, v130, v131
  s_waitcnt lgkmcnt(6)
  v_mfma_f32_32x32x16_bf16 v[96:111], a[96:99], v[184:187], v[96:111]
  ds_read_b128 a[72:75], v5 offset:20480
  buffer_load_dwordx4 v2, s[4:7], s43 offen offset:2048 sc1 lds
  v_add_f32 v22, v22, v130
  v_exp_f32 v133, v133
  v_add_f32 v23, v23, v131
  v_mfma_f32_32x32x16_bf16 v[112:127], a[100:103], v[184:187], v[112:127]
  ds_read_b128 a[76:79], v6 offset:20480
  v_exp_f32 v134, v134
  v_cvt_pk_bf16_f32 v178, v132, v133
  v_add_f32 v22, v22, v132
  s_waitcnt lgkmcnt(4)
  v_mfma_f32_32x32x16_bf16 v[96:111], a[104:107], v[188:191], v[96:111]
  s_waitcnt vmcnt(11)
  ds_read_b128 a[48:51], v3 offset:24576
  buffer_load_dwordx4 v2, s[4:7], s43 offen offset:3072 sc1 lds
  s_add_u32 m0, s16, 0
  v_exp_f32 v135, v135
  v_mfma_f32_32x32x16_bf16 v[112:127], a[108:111], v[188:191], v[112:127]
  ds_read_b128 a[52:55], v4 offset:24576
  v_add_f32 v23, v23, v133
  v_exp_f32 v136, v136
  v_cvt_pk_bf16_f32 v179, v134, v135
  s_waitcnt lgkmcnt(4)
  v_mfma_f32_32x32x16_bf16 v[144:159], a[64:67], a[0:3], v[160:175]
  ds_read_b128 a[56:59], v5 offset:24576
  buffer_load_dwordx4 v2, s[4:7], s44 offen offset:0 sc1 lds
  v_add_f32 v22, v22, v134
  v_exp_f32 v137, v137
  v_add_f32 v23, v23, v135
  v_mfma_f32_32x32x16_bf16 v[144:159], a[68:71], a[4:7], v[144:159]
  ds_read_b128 a[60:63], v6 offset:24576
  v_exp_f32 v138, v138
  v_cvt_pk_bf16_f32 v180, v136, v137
  v_add_f32 v22, v22, v136
  s_waitcnt lgkmcnt(4)
  v_mfma_f32_32x32x16_bf16 v[144:159], a[72:75], a[8:11], v[144:159]
  s_waitcnt vmcnt(9)
  ds_read_b128 a[64:67], v3 offset:28672
  buffer_load_dwordx4 v2, s[4:7], s44 offen offset:1024 sc1 lds
  v_exp_f32 v139, v139
  v_add_f32 v23, v23, v137
  v_mfma_f32_32x32x16_bf16 v[144:159], a[76:79], a[12:15], v[144:159]
  ds_read_b128 a[68:71], v4 offset:28672
  v_exp_f32 v140, v140
  v_cvt_pk_bf16_f32 v181, v138, v139
  v_add_f32 v22, v22, v138
  s_waitcnt lgkmcnt(4)
  v_mfma_f32_32x32x16_bf16 v[144:159], a[48:51], a[16:19], v[144:159]
  ds_read_b128 a[72:75], v5 offset:28672
  buffer_load_dwordx4 v2, s[4:7], s44 offen offset:2048 sc1 lds
  v_exp_f32 v141, v141
  v_add_f32 v23, v23, v139
  v_mfma_f32_32x32x16_bf16 v[144:159], a[52:55], a[20:23], v[144:159]
  ds_read_b128 a[76:79], v6 offset:28672
  v_exp_f32 v142, v142
  v_cvt_pk_bf16_f32 v182, v140, v141
  v_add_f32 v22, v22, v140
  s_waitcnt lgkmcnt(4)
  v_mfma_f32_32x32x16_bf16 v[144:159], a[56:59], a[24:27], v[144:159]
  ds_read_b64_tr_b16 a[80:81], v7 offset:8192
  ds_read_b64_tr_b16 a[82:83], v8 offset:8192
  buffer_load_dwordx4 v2, s[4:7], s44 offen offset:3072 sc1 lds
  s_add_u32 m0, s16, 4096
  v_exp_f32 v143, v143
  v_mfma_f32_32x32x16_bf16 v[144:159], a[60:63], a[28:31], v[144:159]
  ds_read_b64_tr_b16 a[84:85], v9 offset:8192
  ds_read_b64_tr_b16 a[86:87], v10 offset:8192
  v_add_f32 v23, v23, v141
  v_cvt_pk_bf16_f32 v183, v142, v143
  v_add_f32 v22, v22, v142
  s_waitcnt lgkmcnt(6)
  v_mfma_f32_32x32x16_bf16 v[144:159], a[64:67], a[32:35], v[144:159]
  ds_read_b64_tr_b16 a[88:89], v7 offset:10240
  ds_read_b64_tr_b16 a[90:91], v8 offset:10240
  buffer_load_dwordx4 v2, s[4:7], s45 offen offset:0 sc1 lds
  v_add_f32 v23, v23, v143
  v_mfma_f32_32x32x16_bf16 v[144:159], a[68:71], a[36:39], v[144:159]
  ds_read_b64_tr_b16 a[92:93], v9 offset:10240
  ds_read_b64_tr_b16 a[94:95], v10 offset:10240
  s_waitcnt lgkmcnt(8)
  v_mfma_f32_32x32x16_bf16 v[144:159], a[72:75], a[40:43], v[144:159]
  ds_read_b64_tr_b16 a[96:97], v7 offset:12288
  ds_read_b64_tr_b16 a[98:99], v8 offset:12288
  buffer_load_dwordx4 v2, s[4:7], s45 offen offset:1024 sc1 lds
  v_mfma_f32_32x32x16_bf16 v[144:159], a[76:79], a[44:47], v[144:159]
  ds_read_b64_tr_b16 a[100:101], v9 offset:12288
  ds_read_b64_tr_b16 a[102:103], v10 offset:12288
  s_waitcnt lgkmcnt(8)
  v_mfma_f32_32x32x16_bf16 v[32:47], a[80:83], v[176:179], v[32:47]
  ds_read_b64_tr_b16 a[104:105], v7 offset:14336
  ds_read_b64_tr_b16 a[106:107], v8 offset:14336
  buffer_load_dwordx4 v2, s[4:7], s45 offen offset:2048 sc1 lds
  v_mfma_f32_32x32x16_bf16 v[48:63], a[84:87], v[176:179], v[48:63]
  ds_read_b64_tr_b16 a[108:109], v9 offset:14336
  ds_read_b64_tr_b16 a[110:111], v10 offset:14336
  s_waitcnt lgkmcnt(8)
  v_mfma_f32_32x32x16_bf16 v[32:47], a[88:91], v[180:183], v[32:47]
  ds_read_b64_tr_b16 a[80:81], v7 offset:16384
  ds_read_b64_tr_b16 a[82:83], v8 offset:16384
  buffer_load_dwordx4 v2, s[4:7], s45 offen offset:3072 sc1 lds
  s_add_u32 m0, s16, 8192
  v_exp_f32 v144, v144
  v_mfma_f32_32x32x16_bf16 v[48:63], a[92:95], v[180:183], v[48:63]
  ds_read_b64_tr_b16 a[84:85], v9 offset:16384
  ds_read_b64_tr_b16 a[86:87], v10 offset:16384
  v_exp_f32 v145, v145
  s_waitcnt lgkmcnt(8)
  v_mfma_f32_32x32x16_bf16 v[64:79], a[96:99], v[176:179], v[64:79]
  ds_read_b64_tr_b16 a[88:89], v7 offset:18432
  ds_read_b64_tr_b16 a[90:91], v8 offset:18432
  buffer_load_dwordx4 v2, s[4:7], s46 offen offset:0 sc1 lds
  v_exp_f32 v146, v146
  v_cvt_pk_bf16_f32 v184, v144, v145
  v_mfma_f32_32x32x16_bf16 v[80:95], a[100:103], v[176:179], v[80:95]
  ds_read_b64_tr_b16 a[92:93], v9 offset:18432
  ds_read_b64_tr_b16 a[94:95], v10 offset:18432
  v_add_f32 v22, v22, v144
  v_exp_f32 v147, v147
  s_waitcnt lgkmcnt(8)
  v_mfma_f32_32x32x16_bf16 v[64:79], a[104:107], v[180:183], v[64:79]
  s_waitcnt vmcnt(13)
  ds_read_b128 a[48:51], v3 offset:32768
  buffer_load_dwordx4 v2, s[4:7], s46 offen offset:1024 sc1 lds
  v_add_f32 v23, v23, v145
  v_exp_f32 v148, v148
  v_mfma_f32_32x32x16_bf16 v[80:95], a[108:111], v[180:183], v[80:95]
  ds_read_b128 a[52:55], v4 offset:32768
  v_cvt_pk_bf16_f32 v185, v146, v147
  v_add_f32 v22, v22, v146
  v_exp_f32 v149, v149
  s_waitcnt lgkmcnt(6)
  v_mfma_f32_32x32x16_bf16 v[96:111], a[80:83], v[176:179], v[96:111]
  ds_read_b128 a[56:59], v5 offset:32768
  buffer_load_dwordx4 v2, s[4:7], s46 offen offset:2048 sc1 lds
  v_add_f32 v23, v23, v147
  v_exp_f32 v150, v150
  v_cvt_pk_bf16_f32 v186, v148, v149
  v_mfma_f32_32x32x16_bf16 v[112:127], a[84:87], v[176:179], v[112:127]
  ds_read_b128 a[60:63], v6 offset:32768
  v_add_f32 v22, v22, v148
  v_exp_f32 v151, v151
  v_add_f32 v23, v23, v149
  s_waitcnt lgkmcnt(4)
  v_mfma_f32_32x32x16_bf16 v[96:111], a[88:91], v[180:183], v[96:111]
  s_waitcnt vmcnt(11)
  ds_read_b128 a[64:67], v3 offset:36864
  buffer_load_dwordx4 v2, s[4:7], s46 offen offset:3072 sc1 lds
  s_add_u32 m0, s16, 12288
  v_exp_f32 v152, v152
  v_mfma_f32_32x32x16_bf16 v[112:127], a[92:95], v[180:183], v[112:127]
  ds_read_b128 a[68:71], v4 offset:36864
  v_cvt_pk_bf16_f32 v187, v150, v151
  v_add_f32 v22, v22, v150
  v_exp_f32 v153, v153
  s_waitcnt lgkmcnt(4)
  v_mfma_f32_32x32x16_bf16 v[128:143], a[48:51], a[0:3], v[160:175]
  ds_read_b128 a[72:75], v5 offset:36864
  buffer_load_dwordx4 v2, s[4:7], s47 offen offset:0 sc1 lds
  v_add_f32 v23, v23, v151
  v_exp_f32 v154, v154
  v_cvt_pk_bf16_f32 v188, v152, v153
  v_mfma_f32_32x32x16_bf16 v[128:143], a[52:55], a[4:7], v[128:143]
  ds_read_b128 a[76:79], v6 offset:36864
  v_add_f32 v22, v22, v152
  v_exp_f32 v155, v155
  v_add_f32 v23, v23, v153
  s_waitcnt lgkmcnt(4)
  v_mfma_f32_32x32x16_bf16 v[128:143], a[56:59], a[8:11], v[128:143]
  s_waitcnt vmcnt(9)
  ds_read_b128 a[48:51], v3 offset:0
  buffer_load_dwordx4 v2, s[4:7], s47 offen offset:1024 sc1 lds
  v_exp_f32 v156, v156
  v_cvt_pk_bf16_f32 v189, v154, v155
  v_mfma_f32_32x32x16_bf16 v[128:143], a[60:63], a[12:15], v[128:143]
  ds_read_b128 a[52:55], v4 offset:0
  v_add_f32 v22, v22, v154
  v_exp_f32 v157, v157
  v_add_f32 v23, v23, v155
  s_waitcnt lgkmcnt(4)
  v_mfma_f32_32x32x16_bf16 v[128:143], a[64:67], a[16:19], v[128:143]
  ds_read_b128 a[56:59], v5 offset:0
  buffer_load_dwordx4 v2, s[4:7], s47 offen offset:2048 sc1 lds
  v_exp_f32 v158, v158
  v_cvt_pk_bf16_f32 v190, v156, v157
  v_add_f32 v22, v22, v156
  v_mfma_f32_32x32x16_bf16 v[128:143], a[68:71], a[20:23], v[128:143]
  ds_read_b128 a[60:63], v6 offset:0
  v_exp_f32 v159, v159
  v_add_f32 v23, v23, v157
  v_cvt_pk_bf16_f32 v191, v158, v159
  s_waitcnt lgkmcnt(4)
  v_mfma_f32_32x32x16_bf16 v[128:143], a[72:75], a[24:27], v[128:143]
  ds_read_b64_tr_b16 a[96:97], v7 offset:20480
  ds_read_b64_tr_b16 a[98:99], v8 offset:20480
  buffer_load_dwordx4 v2, s[4:7], s47 offen offset:3072 sc1 lds
  v_add_f32 v22, v22, v158
  v_add_f32 v23, v23, v159
  v_mfma_f32_32x32x16_bf16 v[128:143], a[76:79], a[28:31], v[128:143]
  ds_read_b64_tr_b16 a[100:101], v9 offset:20480
  ds_read_b64_tr_b16 a[102:103], v10 offset:20480
  s_waitcnt lgkmcnt(6)
  v_mfma_f32_32x32x16_bf16 v[128:143], a[48:51], a[32:35], v[128:143]
  ds_read_b64_tr_b16 a[104:105], v7 offset:22528
  ds_read_b64_tr_b16 a[106:107], v8 offset:22528
  buffer_load_dwordx4 a[184:187], v2, s[4:7], s88 offen offset:0 sc1
  v_mfma_f32_32x32x16_bf16 v[128:143], a[52:55], a[36:39], v[128:143]
  ds_read_b64_tr_b16 a[108:109], v9 offset:22528
  ds_read_b64_tr_b16 a[110:111], v10 offset:22528
  s_waitcnt lgkmcnt(8)
  v_mfma_f32_32x32x16_bf16 v[128:143], a[56:59], a[40:43], v[128:143]
  ds_read_b64_tr_b16 a[80:81], v7 offset:24576
  ds_read_b64_tr_b16 a[82:83], v8 offset:24576
  buffer_load_dwordx4 a[188:191], v2, s[4:7], s88 offen offset:1024 sc1
  v_mfma_f32_32x32x16_bf16 v[128:143], a[60:63], a[44:47], v[128:143]
  ds_read_b64_tr_b16 a[84:85], v9 offset:24576
  ds_read_b64_tr_b16 a[86:87], v10 offset:24576
  s_waitcnt lgkmcnt(8)
  v_mfma_f32_32x32x16_bf16 v[32:47], a[96:99], v[184:187], v[32:47]
  ds_read_b64_tr_b16 a[88:89], v7 offset:26624
  ds_read_b64_tr_b16 a[90:91], v8 offset:26624
  buffer_load_dwordx4 a[192:195], v2, s[4:7], s88 offen offset:2048 sc1
  v_mfma_f32_32x32x16_bf16 v[48:63], a[100:103], v[184:187], v[48:63]
  ds_read_b64_tr_b16 a[92:93], v9 offset:26624
  ds_read_b64_tr_b16 a[94:95], v10 offset:26624
  s_waitcnt lgkmcnt(8)
  v_mfma_f32_32x32x16_bf16 v[32:47], a[104:107], v[188:191], v[32:47]
  ds_read_b64_tr_b16 a[96:97], v7 offset:28672
  ds_read_b64_tr_b16 a[98:99], v8 offset:28672
  buffer_load_dwordx4 a[196:199], v2, s[4:7], s88 offen offset:3072 sc1
  v_exp_f32 v128, v128
  v_mfma_f32_32x32x16_bf16 v[48:63], a[108:111], v[188:191], v[48:63]
  ds_read_b64_tr_b16 a[100:101], v9 offset:28672
  ds_read_b64_tr_b16 a[102:103], v10 offset:28672
  v_exp_f32 v129, v129
  s_waitcnt lgkmcnt(8)
  v_mfma_f32_32x32x16_bf16 v[64:79], a[80:83], v[184:187], v[64:79]
  ds_read_b64_tr_b16 a[104:105], v7 offset:30720
  ds_read_b64_tr_b16 a[106:107], v8 offset:30720
  s_add_u32 s88, s88, 4096
  buffer_load_dwordx4 a[200:203], v2, s[4:7], s88 offen offset:0 sc1
  v_exp_f32 v130, v130
  v_mfma_f32_32x32x16_bf16 v[80:95], a[84:87], v[184:187], v[80:95]
  ds_read_b64_tr_b16 a[108:109], v9 offset:30720
  ds_read_b64_tr_b16 a[110:111], v10 offset:30720
  v_cvt_pk_bf16_f32 v176, v128, v129
  v_add_f32 v22, v22, v128
  s_waitcnt lgkmcnt(8)
  v_mfma_f32_32x32x16_bf16 v[64:79], a[88:91], v[188:191], v[64:79]
  s_waitcnt vmcnt(13)
  ds_read_b128 a[64:67], v3 offset:4096
  buffer_load_dwordx4 a[204:207], v2, s[4:7], s88 offen offset:1024 sc1
  v_exp_f32 v131, v131
  v_add_f32 v23, v23, v129
  v_mfma_f32_32x32x16_bf16 v[80:95], a[92:95], v[188:191], v[80:95]
  ds_read_b128 a[68:71], v4 offset:4096
  v_exp_f32 v132, v132
  v_cvt_pk_bf16_f32 v177, v130, v131
  v_add_f32 v22, v22, v130
  s_waitcnt lgkmcnt(6)
  v_mfma_f32_32x32x16_bf16 v[96:111], a[96:99], v[184:187], v[96:111]
  ds_read_b128 a[72:75], v5 offset:4096
  buffer_load_dwordx4 a[208:211], v2, s[4:7], s88 offen offset:2048 sc1
  v_exp_f32 v133, v133
  v_add_f32 v23, v23, v131
  v_mfma_f32_32x32x16_bf16 v[112:127], a[100:103], v[184:187], v[112:127]
  ds_read_b128 a[76:79], v6 offset:4096
  v_exp_f32 v134, v134
  v_cvt_pk_bf16_f32 v178, v132, v133
  v_add_f32 v22, v22, v132
  s_waitcnt lgkmcnt(4)
  v_mfma_f32_32x32x16_bf16 v[96:111], a[104:107], v[188:191], v[96:111]
  s_waitcnt vmcnt(11)
  ds_read_b128 a[48:51], v3 offset:8192
  buffer_load_dwordx4 a[212:215], v2, s[4:7], s88 offen offset:3072 sc1
  v_exp_f32 v135, v135
  v_add_f32 v23, v23, v133
  v_mfma_f32_32x32x16_bf16 v[112:127], a[108:111], v[188:191], v[112:127]
  ds_read_b128 a[52:55], v4 offset:8192
  v_exp_f32 v136, v136
  v_cvt_pk_bf16_f32 v179, v134, v135
  v_add_f32 v22, v22, v134
  s_waitcnt lgkmcnt(4)
  v_mfma_f32_32x32x16_bf16 v[144:159], a[64:67], a[0:3], v[160:175]
  ds_read_b128 a[56:59], v5 offset:8192
  s_add_u32 s88, s88, 4096
  buffer_load_dwordx4 a[216:219], v2, s[4:7], s88 offen offset:0 sc1
  v_exp_f32 v137, v137
  v_add_f32 v23, v23, v135
  v_mfma_f32_32x32x16_bf16 v[144:159], a[68:71], a[4:7], v[144:159]
  ds_read_b128 a[60:63], v6 offset:8192
  v_exp_f32 v138, v138
  v_cvt_pk_bf16_f32 v180, v136, v137
  v_add_f32 v22, v22, v136
  s_waitcnt lgkmcnt(4)
  v_mfma_f32_32x32x16_bf16 v[144:159], a[72:75], a[8:11], v[144:159]
  s_waitcnt vmcnt(9)
  ds_read_b128 a[64:67], v3 offset:12288
  buffer_load_dwordx4 a[220:223], v2, s[4:7], s88 offen offset:1024 sc1
  v_exp_f32 v139, v139
  v_add_f32 v23, v23, v137
  v_mfma_f32_32x32x16_bf16 v[144:159], a[76:79], a[12:15], v[144:159]
  ds_read_b128 a[68:71], v4 offset:12288
  v_exp_f32 v140, v140
  v_cvt_pk_bf16_f32 v181, v138, v139
  v_add_f32 v22, v22, v138
  s_waitcnt lgkmcnt(4)
  v_mfma_f32_32x32x16_bf16 v[144:159], a[48:51], a[16:19], v[144:159]
  ds_read_b128 a[72:75], v5 offset:12288
  buffer_load_dwordx4 a[224:227], v2, s[4:7], s88 offen offset:2048 sc1
  v_exp_f32 v141, v141
  v_add_f32 v23, v23, v139
  v_mfma_f32_32x32x16_bf16 v[144:159], a[52:55], a[20:23], v[144:159]
  ds_read_b128 a[76:79], v6 offset:12288
  v_exp_f32 v142, v142
  v_cvt_pk_bf16_f32 v182, v140, v141
  v_add_f32 v22, v22, v140
  s_waitcnt lgkmcnt(4)
  v_mfma_f32_32x32x16_bf16 v[144:159], a[56:59], a[24:27], v[144:159]
  ds_read_b64_tr_b16 a[80:81], v7 offset:32768
  ds_read_b64_tr_b16 a[82:83], v8 offset:32768
  buffer_load_dwordx4 a[228:231], v2, s[4:7], s88 offen offset:3072 sc1
  v_exp_f32 v143, v143
  v_add_f32 v23, v23, v141
  v_mfma_f32_32x32x16_bf16 v[144:159], a[60:63], a[28:31], v[144:159]
  ds_read_b64_tr_b16 a[84:85], v9 offset:32768
  ds_read_b64_tr_b16 a[86:87], v10 offset:32768
  v_cvt_pk_bf16_f32 v183, v142, v143
  v_add_f32 v22, v22, v142
  v_add_f32 v23, v23, v143
  s_waitcnt lgkmcnt(6)
  v_mfma_f32_32x32x16_bf16 v[144:159], a[64:67], a[32:35], v[144:159]
  ds_read_b64_tr_b16 a[88:89], v7 offset:34816
  ds_read_b64_tr_b16 a[90:91], v8 offset:34816
  s_add_u32 s88, s88, 4096
  buffer_load_dwordx4 a[232:235], v2, s[4:7], s88 offen offset:0 sc1
  v_mfma_f32_32x32x16_bf16 v[144:159], a[68:71], a[36:39], v[144:159]
  ds_read_b64_tr_b16 a[92:93], v9 offset:34816
  ds_read_b64_tr_b16 a[94:95], v10 offset:34816
  s_waitcnt lgkmcnt(8)
  v_mfma_f32_32x32x16_bf16 v[144:159], a[72:75], a[40:43], v[144:159]
  ds_read_b64_tr_b16 a[96:97], v7 offset:36864
  ds_read_b64_tr_b16 a[98:99], v8 offset:36864
  buffer_load_dwordx4 a[236:239], v2, s[4:7], s88 offen offset:1024 sc1
  v_mfma_f32_32x32x16_bf16 v[144:159], a[76:79], a[44:47], v[144:159]
  ds_read_b64_tr_b16 a[100:101], v9 offset:36864
  ds_read_b64_tr_b16 a[102:103], v10 offset:36864
  s_waitcnt lgkmcnt(8)
  v_mfma_f32_32x32x16_bf16 v[32:47], a[80:83], v[176:179], v[32:47]
  ds_read_b64_tr_b16 a[104:105], v7 offset:38912
  ds_read_b64_tr_b16 a[106:107], v8 offset:38912
  buffer_load_dwordx4 a[240:243], v2, s[4:7], s88 offen offset:2048 sc1
  v_mfma_f32_32x32x16_bf16 v[48:63], a[84:87], v[176:179], v[48:63]
  ds_read_b64_tr_b16 a[108:109], v9 offset:38912
  ds_read_b64_tr_b16 a[110:111], v10 offset:38912
  s_waitcnt lgkmcnt(8)
  v_mfma_f32_32x32x16_bf16 v[32:47], a[88:91], v[180:183], v[32:47]
  ds_read_b64_tr_b16 a[80:81], v7 offset:0
  ds_read_b64_tr_b16 a[82:83], v8 offset:0
  buffer_load_dwordx4 a[244:247], v2, s[4:7], s88 offen offset:3072 sc1
  v_exp_f32 v144, v144
  v_exp_f32 v145, v145
  v_mfma_f32_32x32x16_bf16 v[48:63], a[92:95], v[180:183], v[48:63]
  ds_read_b64_tr_b16 a[84:85], v9 offset:0
  ds_read_b64_tr_b16 a[86:87], v10 offset:0
  v_exp_f32 v146, v146
  v_cvt_pk_bf16_f32 v184, v144, v145
  v_add_f32 v22, v22, v144
  s_waitcnt lgkmcnt(8)
  v_mfma_f32_32x32x16_bf16 v[64:79], a[96:99], v[176:179], v[64:79]
  ds_read_b64_tr_b16 a[88:89], v7 offset:2048
  ds_read_b64_tr_b16 a[90:91], v8 offset:2048
  s_add_u32 s88, s88, 4096
  buffer_load_dwordx4 a[248:251], v2, s[4:7], s88 offen offset:0 sc1
  v_exp_f32 v147, v147
  v_add_f32 v23, v23, v145
  v_mfma_f32_32x32x16_bf16 v[80:95], a[100:103], v[176:179], v[80:95]
  ds_read_b64_tr_b16 a[92:93], v9 offset:2048
  ds_read_b64_tr_b16 a[94:95], v10 offset:2048
  v_exp_f32 v148, v148
  v_cvt_pk_bf16_f32 v185, v146, v147
  v_add_f32 v22, v22, v146
  s_waitcnt lgkmcnt(8)
  v_mfma_f32_32x32x16_bf16 v[64:79], a[104:107], v[180:183], v[64:79]
  ds_read_b64_tr_b16 a[96:97], v7 offset:4096
  ds_read_b64_tr_b16 a[98:99], v8 offset:4096
  buffer_load_dwordx4 a[252:255], v2, s[4:7], s88 offen offset:1024 sc1
  v_exp_f32 v149, v149
  v_add_f32 v23, v23, v147
  v_exp_f32 v150, v150
  v_mfma_f32_32x32x16_bf16 v[80:95], a[108:111], v[180:183], v[80:95]
  ds_read_b64_tr_b16 a[100:101], v9 offset:4096
  ds_read_b64_tr_b16 a[102:103], v10 offset:4096
  v_cvt_pk_bf16_f32 v186, v148, v149
  v_add_f32 v22, v22, v148
  v_exp_f32 v151, v151
  v_add_f32 v23, v23, v149
  s_waitcnt lgkmcnt(8)
  v_mfma_f32_32x32x16_bf16 v[96:111], a[80:83], v[176:179], v[96:111]
  ds_read_b64_tr_b16 a[104:105], v7 offset:6144
  ds_read_b64_tr_b16 a[106:107], v8 offset:6144
  v_exp_f32 v152, v152
  v_cvt_pk_bf16_f32 v187, v150, v151
  v_add_f32 v22, v22, v150
  v_exp_f32 v153, v153
  v_mfma_f32_32x32x16_bf16 v[112:127], a[84:87], v[176:179], v[112:127]
  ds_read_b64_tr_b16 a[108:109], v9 offset:6144
  ds_read_b64_tr_b16 a[110:111], v10 offset:6144
  v_add_f32 v23, v23, v151
  v_exp_f32 v154, v154
  v_cvt_pk_bf16_f32 v188, v152, v153
  v_add_f32 v22, v22, v152
  s_waitcnt lgkmcnt(8)
  v_mfma_f32_32x32x16_bf16 v[96:111], a[88:91], v[180:183], v[96:111]
  ds_read_b64_tr_b16 a[80:81], v7 offset:8192
  ds_read_b64_tr_b16 a[82:83], v8 offset:8192
  v_exp_f32 v155, v155
  v_add_f32 v23, v23, v153
  v_exp_f32 v156, v156
  v_cvt_pk_bf16_f32 v189, v154, v155
  v_mfma_f32_32x32x16_bf16 v[112:127], a[92:95], v[180:183], v[112:127]
  ds_read_b64_tr_b16 a[84:85], v9 offset:8192
  ds_read_b64_tr_b16 a[86:87], v10 offset:8192
  v_add_f32 v22, v22, v154
  v_exp_f32 v157, v157
  v_add_f32 v23, v23, v155
  s_waitcnt lgkmcnt(8)
  v_mfma_f32_32x32x16_bf16 v[32:47], a[96:99], v[184:187], v[32:47]
  ds_read_b64_tr_b16 a[88:89], v7 offset:10240
  ds_read_b64_tr_b16 a[90:91], v8 offset:10240
  v_exp_f32 v158, v158
  v_cvt_pk_bf16_f32 v190, v156, v157
  v_add_f32 v22, v22, v156
  v_exp_f32 v159, v159
  v_mfma_f32_32x32x16_bf16 v[48:63], a[100:103], v[184:187], v[48:63]
  ds_read_b64_tr_b16 a[92:93], v9 offset:10240
  ds_read_b64_tr_b16 a[94:95], v10 offset:10240
  v_add_f32 v23, v23, v157
  v_cvt_pk_bf16_f32 v191, v158, v159
  v_add_f32 v22, v22, v158
  v_add_f32 v23, v23, v159
  s_waitcnt lgkmcnt(8)
  v_mfma_f32_32x32x16_bf16 v[32:47], a[104:107], v[188:191], v[32:47]
  ds_read_b64_tr_b16 a[96:97], v7 offset:12288
  ds_read_b64_tr_b16 a[98:99], v8 offset:12288
  v_lshlrev_b32 v160, 16, v224
  v_and_b32 v161, 0xffff0000, v224
  v_lshlrev_b32 v162, 16, v225
  v_and_b32 v163, 0xffff0000, v225
  v_lshlrev_b32 v164, 16, v226
  v_and_b32 v165, 0xffff0000, v226
  v_lshlrev_b32 v166, 16, v227
  v_and_b32 v167, 0xffff0000, v227
  v_mfma_f32_32x32x16_bf16 v[48:63], a[108:111], v[188:191], v[48:63]
  ds_read_b64_tr_b16 a[100:101], v7 offset:14336
  ds_read_b64_tr_b16 a[102:103], v8 offset:14336
  v_lshlrev_b32 v168, 16, v232
  v_and_b32 v169, 0xffff0000, v232
  v_lshlrev_b32 v170, 16, v233
  v_and_b32 v171, 0xffff0000, v233
  v_lshlrev_b32 v172, 16, v228
  v_and_b32 v173, 0xffff0000, v228
  v_lshlrev_b32 v174, 16, v229
  v_and_b32 v175, 0xffff0000, v229
  s_waitcnt lgkmcnt(8)
  v_mfma_f32_32x32x16_bf16 v[64:79], a[80:83], v[184:187], v[64:79]
  ds_read_b64_tr_b16 a[104:105], v9 offset:12288
  ds_read_b64_tr_b16 a[106:107], v10 offset:12288
  v_lshlrev_b32 v176, 16, v230
  v_and_b32 v177, 0xffff0000, v230
  v_lshlrev_b32 v178, 16, v231
  v_and_b32 v179, 0xffff0000, v231
  v_lshlrev_b32 v180, 16, v234
  v_and_b32 v181, 0xffff0000, v234
  v_lshlrev_b32 v182, 16, v235
  v_and_b32 v183, 0xffff0000, v235
  v_mfma_f32_32x32x16_bf16 v[80:95], a[84:87], v[184:187], v[80:95]
  ds_read_b64_tr_b16 a[108:109], v9 offset:14336
  ds_read_b64_tr_b16 a[110:111], v10 offset:14336
  v_add_f32 v22, v22, v23
  v_mov_b32 v23, v22
  s_nop 1
  v_permlane32_swap_b32 v22, v23
  v_add_f32 v22, v22, v23
  ds_write_b32 v19, v22
  v_fma_f32 v160, v160, v236, v237
  v_fma_f32 v161, v161, v236, v237
  v_fma_f32 v162, v162, v236, v237
  v_fma_f32 v163, v163, v236, v237
  v_fma_f32 v164, v164, v236, v237
  v_fma_f32 v165, v165, v236, v237
  v_fma_f32 v166, v166, v236, v237
  v_fma_f32 v167, v167, v236, v237
  s_waitcnt lgkmcnt(9)
  v_mfma_f32_32x32x16_bf16 v[64:79], a[88:91], v[188:191], v[64:79]
  v_cvt_pk_bf16_f32 v192, v32, v33
  v_cvt_pk_bf16_f32 v193, v34, v35
  v_cvt_pk_bf16_f32 v194, v36, v37
  v_cvt_pk_bf16_f32 v195, v38, v39
  ds_write_b128 v14, v[192:195] offset:0
  v_cvt_pk_bf16_f32 v196, v40, v41
  v_cvt_pk_bf16_f32 v197, v42, v43
  v_cvt_pk_bf16_f32 v198, v44, v45
  v_cvt_pk_bf16_f32 v199, v46, v47
  ds_write_b128 v14, v[196:199] offset:1024
  v_mfma_f32_32x32x16_bf16 v[80:95], a[92:95], v[188:191], v[80:95]
  v_cvt_pk_bf16_f32 v200, v48, v49
  v_cvt_pk_bf16_f32 v201, v50, v51
  v_cvt_pk_bf16_f32 v202, v52, v53
  v_cvt_pk_bf16_f32 v203, v54, v55
  ds_write_b128 v14, v[200:203] offset:2048
  v_cvt_pk_bf16_f32 v204, v56, v57
  v_cvt_pk_bf16_f32 v205, v58, v59
  v_cvt_pk_bf16_f32 v206, v60, v61
  v_cvt_pk_bf16_f32 v207, v62, v63
  ds_write_b128 v14, v[204:207] offset:3072
  s_waitcnt lgkmcnt(9)
  v_mfma_f32_32x32x16_bf16 v[96:111], a[96:99], v[184:187], v[96:111]
  v_fma_f32 v168, v168, v236, v237
  v_fma_f32 v169, v169, v236, v237
  v_fma_f32 v170, v170, v236, v237
  v_fma_f32 v171, v171, v236, v237
  v_fma_f32 v172, v172, v238, v239
  v_fma_f32 v173, v173, v238, v239
  v_fma_f32 v174, v174, v238, v239
  v_fma_f32 v175, v175, v238, v239
  v_mfma_f32_32x32x16_bf16 v[96:111], a[100:103], v[188:191], v[96:111]
  v_fma_f32 v176, v176, v238, v239
  v_fma_f32 v177, v177, v238, v239
  v_fma_f32 v178, v178, v238, v239
  v_fma_f32 v179, v179, v238, v239
  v_fma_f32 v180, v180, v238, v239
  v_fma_f32 v181, v181, v238, v239
  v_fma_f32 v182, v182, v238, v239
  v_fma_f32 v183, v183, v238, v239
  s_waitcnt lgkmcnt(5)
  v_mfma_f32_32x32x16_bf16 v[112:127], a[104:107], v[184:187], v[112:127]
  v_cvt_pk_bf16_f32 v192, v64, v65
  v_cvt_pk_bf16_f32 v193, v66, v67
  v_cvt_pk_bf16_f32 v194, v68, v69
  v_cvt_pk_bf16_f32 v195, v70, v71
  ds_write_b128 v14, v[192:195] offset:4096
  v_cvt_pk_bf16_f32 v196, v72, v73
  v_cvt_pk_bf16_f32 v197, v74, v75
  v_cvt_pk_bf16_f32 v198, v76, v77
  v_cvt_pk_bf16_f32 v199, v78, v79
  ds_write_b128 v14, v[196:199] offset:5120
  v_mfma_f32_32x32x16_bf16 v[112:127], a[108:111], v[188:191], v[112:127]
  v_cvt_pk_bf16_f32 v200, v80, v81
  v_cvt_pk_bf16_f32 v201, v82, v83
  v_cvt_pk_bf16_f32 v202, v84, v85
  v_cvt_pk_bf16_f32 v203, v86, v87
  ds_write_b128 v14, v[200:203] offset:6144
  v_cvt_pk_bf16_f32 v204, v88, v89
  v_cvt_pk_bf16_f32 v205, v90, v91
  v_cvt_pk_bf16_f32 v206, v92, v93
  v_cvt_pk_bf16_f32 v207, v94, v95
  ds_write_b128 v14, v[204:207] offset:7168
  v_cvt_pk_bf16_f32 v192, v96, v97
  v_cvt_pk_bf16_f32 v193, v98, v99
  v_cvt_pk_bf16_f32 v194, v100, v101
  v_cvt_pk_bf16_f32 v195, v102, v103
  ds_write_b128 v14, v[192:195] offset:8192
  v_cvt_pk_bf16_f32 v196, v104, v105
  v_cvt_pk_bf16_f32 v197, v106, v107
  v_cvt_pk_bf16_f32 v198, v108, v109
  v_cvt_pk_bf16_f32 v199, v110, v111
  ds_write_b128 v14, v[196:199] offset:9216
  v_cvt_pk_bf16_f32 v200, v112, v113
  v_cvt_pk_bf16_f32 v201, v114, v115
  v_cvt_pk_bf16_f32 v202, v116, v117
  v_cvt_pk_bf16_f32 v203, v118, v119
  ds_write_b128 v14, v[200:203] offset:10240
  v_cvt_pk_bf16_f32 v204, v120, v121
  v_cvt_pk_bf16_f32 v205, v122, v123
  v_cvt_pk_bf16_f32 v206, v124, v125
  v_cvt_pk_bf16_f32 v207, v126, v127
  ds_write_b128 v14, v[204:207] offset:11264
  s_waitcnt lgkmcnt(0)
  s_barrier
  ds_read_b128 a[0:3], v12 offset:0
  ds_read_b128 a[4:7], v13 offset:0
  ds_read_b128 a[8:11], v12 offset:256
  ds_read_b128 a[12:15], v13 offset:256
  ds_read_b128 a[16:19], v12 offset:1024
  ds_read_b128 a[20:23], v13 offset:1024
  ds_read_b128 a[24:27], v12 offset:1280
  ds_read_b128 a[28:31], v13 offset:1280
  ds_read_b128 a[32:35], v12 offset:2048
  ds_read_b128 a[36:39], v13 offset:2048
  ds_read_b128 a[40:43], v12 offset:2304
  ds_read_b128 a[44:47], v13 offset:2304
  ds_read_b32 v24, v20 offset:0
  ds_read_b32 v25, v20 offset:64
  s_waitcnt lgkmcnt(13)
  v_mfma_f32_16x16x32_bf16 v[128:131], v[248:251], a[0:3], 0
  s_waitcnt lgkmcnt(12)
  v_mfma_f32_16x16x32_bf16 v[128:131], v[248:251], a[4:7], v[128:131]
  s_waitcnt lgkmcnt(11)
  v_mfma_f32_16x16x32_bf16 v[132:135], v[248:251], a[8:11], 0
  s_waitcnt lgkmcnt(10)
  v_mfma_f32_16x16x32_bf16 v[132:135], v[248:251], a[12:15], v[132:135]
  s_waitcnt lgkmcnt(9)
  v_mfma_f32_16x16x32_bf16 v[136:139], v[248:251], a[16:19], 0
  s_waitcnt lgkmcnt(8)
  v_mfma_f32_16x16x32_bf16 v[136:139], v[248:251], a[20:23], v[136:139]
  s_waitcnt lgkmcnt(7)
  v_mfma_f32_16x16x32_bf16 v[140:143], v[248:251], a[24:27], 0
  s_waitcnt lgkmcnt(6)
  v_mfma_f32_16x16x32_bf16 v[140:143], v[248:251], a[28:31], v[140:143]
  s_waitcnt lgkmcnt(5)
  v_mfma_f32_16x16x32_bf16 v[144:147], v[248:251], a[32:35], 0
  s_waitcnt lgkmcnt(4)
  v_mfma_f32_16x16x32_bf16 v[144:147], v[248:251], a[36:39], v[144:147]
  s_waitcnt lgkmcnt(3)
  v_mfma_f32_16x16x32_bf16 v[148:151], v[248:251], a[40:43], 0
  s_waitcnt lgkmcnt(2)
  v_mfma_f32_16x16x32_bf16 v[148:151], v[248:251], a[44:47], v[148:151]
  v_cvt_pk_bf16_f32 v192, v128, v129
  v_cvt_pk_bf16_f32 v193, v130, v131
  v_cvt_pk_bf16_f32 v194, v136, v137
  v_cvt_pk_bf16_f32 v195, v138, v139
  ds_write_b128 v15, v[192:195] offset:0
  v_cvt_pk_bf16_f32 v196, v132, v133
  v_cvt_pk_bf16_f32 v197, v134, v135
  v_cvt_pk_bf16_f32 v198, v140, v141
  v_cvt_pk_bf16_f32 v199, v142, v143
  ds_write_b128 v15, v[196:199] offset:1024
  v_cvt_pk_bf16_f32 v200, v144, v145
  v_cvt_pk_bf16_f32 v201, v146, v147
  ds_write_b64 v16, v[200:201] offset:0
  v_cvt_pk_bf16_f32 v202, v148, v149
  v_cvt_pk_bf16_f32 v203, v150, v151
  ds_write_b64 v16, v[202:203] offset:1024
  s_waitcnt lgkmcnt(5)
  v_mov_b32 v26, v24
  s_nop 1
  v_permlane16_swap_b32 v24, v26
  v_add_f32 v24, v24, v26
  v_mov_b32 v26, v24
  s_nop 1
  v_permlane32_swap_b32 v24, v26
  v_add_f32 v24, v24, v26
  v_rcp_f32 v24, v24
  s_waitcnt lgkmcnt(4)
  v_mov_b32 v27, v25
  s_nop 1
  v_permlane16_swap_b32 v25, v27
  v_add_f32 v25, v25, v27
  v_mov_b32 v27, v25
  s_nop 1
  v_permlane32_swap_b32 v25, v27
  v_add_f32 v25, v25, v27
  v_rcp_f32 v25, v25
  s_waitcnt lgkmcnt(0)
  s_barrier
  ds_read_b128 a[48:51], v2 offset:0
  ds_read_b128 a[56:59], v2 offset:2048
  ds_read_b128 a[64:67], v2 offset:4096
  ds_read_b128 a[72:75], v2 offset:6144
  ds_read_b128 a[80:83], v2 offset:8192
  ds_read_b128 a[88:91], v2 offset:10240
  ds_read_b128 a[52:55], v2 offset:1024
  ds_read_b128 a[60:63], v2 offset:3072
  ds_read_b128 a[68:71], v2 offset:5120
  ds_read_b128 a[76:79], v2 offset:7168
  ds_read_b128 a[84:87], v2 offset:9216
  ds_read_b128 a[92:95], v2 offset:11264
  s_add_u32 s18, s22, 6144
  s_waitcnt vmcnt(17) lgkmcnt(11)
  v_mfma_f32_16x16x32_bf16 v[32:35], a[184:187], a[48:51], 0
  s_waitcnt vmcnt(16) lgkmcnt(10)
  v_mfma_f32_16x16x32_bf16 v[32:35], a[188:191], a[56:59], v[32:35]
  s_waitcnt vmcnt(15) lgkmcnt(9)
  v_mfma_f32_16x16x32_bf16 v[32:35], a[192:195], a[64:67], v[32:35]
  s_waitcnt vmcnt(14) lgkmcnt(8)
  v_mfma_f32_16x16x32_bf16 v[32:35], a[196:199], a[72:75], v[32:35]
  s_waitcnt vmcnt(13) lgkmcnt(7)
  v_mfma_f32_16x16x32_bf16 v[32:35], a[200:203], a[80:83], v[32:35]
  s_waitcnt vmcnt(12) lgkmcnt(6)
  v_mfma_f32_16x16x32_bf16 v[32:35], a[204:207], a[88:91], v[32:35]
  s_waitcnt vmcnt(11)
  v_mfma_f32_16x16x32_bf16 v[36:39], a[208:211], a[48:51], 0
  s_waitcnt vmcnt(10)
  v_mfma_f32_16x16x32_bf16 v[36:39], a[212:215], a[56:59], v[36:39]
  s_waitcnt vmcnt(9)
  v_mfma_f32_16x16x32_bf16 v[36:39], a[216:219], a[64:67], v[36:39]
  s_waitcnt vmcnt(8)
  v_mfma_f32_16x16x32_bf16 v[36:39], a[220:223], a[72:75], v[36:39]
  v_fma_f32 v160, v32, v24, v160
  v_fma_f32 v161, v33, v24, v161
  v_fma_f32 v162, v34, v24, v162
  s_waitcnt vmcnt(7)
  v_mfma_f32_16x16x32_bf16 v[36:39], a[224:227], a[80:83], v[36:39]
  v_fma_f32 v163, v35, v24, v163
  v_cvt_pk_bf16_f32 v208, v160, v161
  v_cvt_pk_bf16_f32 v209, v162, v163
  s_waitcnt vmcnt(6)
  v_mfma_f32_16x16x32_bf16 v[36:39], a[228:231], a[88:91], v[36:39]
  s_waitcnt vmcnt(5)
  v_mfma_f32_16x16x32_bf16 v[40:43], a[232:235], a[48:51], 0
  s_waitcnt vmcnt(4)
  v_mfma_f32_16x16x32_bf16 v[40:43], a[236:239], a[56:59], v[40:43]
  s_waitcnt vmcnt(3)
  v_mfma_f32_16x16x32_bf16 v[40:43], a[240:243], a[64:67], v[40:43]
  s_waitcnt vmcnt(2)
  v_mfma_f32_16x16x32_bf16 v[40:43], a[244:247], a[72:75], v[40:43]
  v_fma_f32 v164, v36, v24, v164
  v_fma_f32 v165, v37, v24, v165
  v_fma_f32 v166, v38, v24, v166
  s_waitcnt vmcnt(1)
  v_mfma_f32_16x16x32_bf16 v[40:43], a[248:251], a[80:83], v[40:43]
  v_fma_f32 v167, v39, v24, v167
  v_cvt_pk_bf16_f32 v210, v164, v165
  v_cvt_pk_bf16_f32 v211, v166, v167
  s_waitcnt vmcnt(0)
  v_mfma_f32_16x16x32_bf16 v[40:43], a[252:255], a[88:91], v[40:43]
  buffer_store_dwordx4 v[208:211], v17, s[8:11], s22 offen
  s_waitcnt lgkmcnt(5)
  v_mfma_f32_16x16x32_bf16 v[44:47], a[184:187], a[52:55], 0
  s_waitcnt lgkmcnt(4)
  v_mfma_f32_16x16x32_bf16 v[44:47], a[188:191], a[60:63], v[44:47]
  s_waitcnt lgkmcnt(3)
  v_mfma_f32_16x16x32_bf16 v[44:47], a[192:195], a[68:71], v[44:47]
  s_waitcnt lgkmcnt(2)
  v_mfma_f32_16x16x32_bf16 v[44:47], a[196:199], a[76:79], v[44:47]
  v_fma_f32 v168, v40, v24, v168
  v_fma_f32 v169, v41, v24, v169
  v_fma_f32 v170, v42, v24, v170
  s_waitcnt lgkmcnt(1)
  v_mfma_f32_16x16x32_bf16 v[44:47], a[200:203], a[84:87], v[44:47]
  v_fma_f32 v171, v43, v24, v171
  v_cvt_pk_bf16_f32 v212, v168, v169
  v_cvt_pk_bf16_f32 v213, v170, v171
  s_waitcnt lgkmcnt(0)
  v_mfma_f32_16x16x32_bf16 v[44:47], a[204:207], a[92:95], v[44:47]
  buffer_store_dwordx2 v[212:213], v18, s[8:11], s22 offen
  v_mfma_f32_16x16x32_bf16 v[48:51], a[208:211], a[52:55], 0
  v_mfma_f32_16x16x32_bf16 v[48:51], a[212:215], a[60:63], v[48:51]
  v_mfma_f32_16x16x32_bf16 v[48:51], a[216:219], a[68:71], v[48:51]
  v_mfma_f32_16x16x32_bf16 v[48:51], a[220:223], a[76:79], v[48:51]
  s_nop 2
  v_fma_f32 v172, v44, v25, v172
  v_fma_f32 v173, v45, v25, v173
  v_fma_f32 v174, v46, v25, v174
  v_mfma_f32_16x16x32_bf16 v[48:51], a[224:227], a[84:87], v[48:51]
  v_fma_f32 v175, v47, v25, v175
  v_cvt_pk_bf16_f32 v216, v172, v173
  v_cvt_pk_bf16_f32 v217, v174, v175
  v_mfma_f32_16x16x32_bf16 v[48:51], a[228:231], a[92:95], v[48:51]
  v_mfma_f32_16x16x32_bf16 v[52:55], a[232:235], a[52:55], 0
  v_mfma_f32_16x16x32_bf16 v[52:55], a[236:239], a[60:63], v[52:55]
  v_mfma_f32_16x16x32_bf16 v[52:55], a[240:243], a[68:71], v[52:55]
  v_mfma_f32_16x16x32_bf16 v[52:55], a[244:247], a[76:79], v[52:55]
  s_nop 3
  v_fma_f32 v176, v48, v25, v176
  v_fma_f32 v177, v49, v25, v177
  v_fma_f32 v178, v50, v25, v178
  v_mfma_f32_16x16x32_bf16 v[52:55], a[248:251], a[84:87], v[52:55]
  v_fma_f32 v179, v51, v25, v179
  v_cvt_pk_bf16_f32 v218, v176, v177
  v_cvt_pk_bf16_f32 v219, v178, v179
  v_mfma_f32_16x16x32_bf16 v[52:55], a[252:255], a[92:95], v[52:55]
  buffer_store_dwordx4 v[216:219], v17, s[8:11], s18 offen
  s_nop 6
  v_fma_f32 v180, v52, v25, v180
  v_fma_f32 v181, v53, v25, v181
  v_fma_f32 v182, v54, v25, v182
  v_fma_f32 v183, v55, v25, v183
  v_cvt_pk_bf16_f32 v220, v180, v181
  v_cvt_pk_bf16_f32 v221, v182, v183
  buffer_store_dwordx2 v[220:221], v18, s[8:11], s18 offen
  s_endpgm
ts_b_wsl:
  s_mov_b32 s93, 20000
ts_b_wsl1:
  buffer_load_dword v31, v21, s[4:7], 0 offen sc1
  s_sub_u32 s93, s93, 1
  s_cbranch_scc1 ts_b_wsl2
  s_waitcnt vmcnt(0)
  v_cmp_ne_u32 vcc, s98, v31
  s_nop 4
  s_cbranch_vccnz ts_b_wsl1
ts_b_wsl2:
  s_waitcnt vmcnt(0)
  s_branch ts_b_wbk
ts_b_fb:
  s_waitcnt vmcnt(0) lgkmcnt(0)
  s_barrier
  ds_read_b128 a[16:19], v85 offset:41984
  ds_read_b128 a[20:23], v85 offset:43008
  ds_read_b128 a[24:27], v86 offset:0
  ds_read_b128 a[28:31], v86 offset:1024
  ds_read_b128 a[32:35], v86 offset:2048
  ds_read_b128 a[36:39], v86 offset:40960
  ds_read_b128 a[40:43], v86 offset:41984
  ds_read_b128 a[44:47], v86 offset:43008
  v_mov_b32 v26, 0xff61b1e6
  s_mov_b32 s23, 0
ts_b_fbl:
  s_mul_i32 s19, s23, 12288
  s_add_u32 s19, s19, s21
  s_add_u32 m0, s16, 0
  s_add_u32 s18, s19, 0
  buffer_load_dwordx4 v2, s[4:7], s18 offen offset:0 sc1 lds
  buffer_load_dwordx4 v2, s[4:7], s18 offen offset:1024 sc1 lds
  buffer_load_dwordx4 v2, s[4:7], s18 offen offset:2048 sc1 lds
  buffer_load_dwordx4 v2, s[4:7], s18 offen offset:3072 sc1 lds
  s_add_u32 m0, s16, 4096
  s_add_u32 s18, s19, 4096
  buffer_load_dwordx4 v2, s[4:7], s18 offen offset:0 sc1 lds
  buffer_load_dwordx4 v2, s[4:7], s18 offen offset:1024 sc1 lds
  buffer_load_dwordx4 v2, s[4:7], s18 offen offset:2048 sc1 lds
  buffer_load_dwordx4 v2, s[4:7], s18 offen offset:3072 sc1 lds
  s_add_u32 m0, s16, 8192
  s_add_u32 s18, s19, 8192
  buffer_load_dwordx4 v2, s[4:7], s18 offen offset:0 sc1 lds
  buffer_load_dwordx4 v2, s[4:7], s18 offen offset:1024 sc1 lds
  buffer_load_dwordx4 v2, s[4:7], s18 offen offset:2048 sc1 lds
  buffer_load_dwordx4 v2, s[4:7], s18 offen offset:3072 sc1 lds
  s_waitcnt vmcnt(0)
  ds_read_b128 a[48:51], v3 offset:0
  s_waitcnt lgkmcnt(0)
  v_mfma_f32_32x32x16_bf16 v[128:143], a[48:51], a[0:3], 0
  ds_read_b128 a[52:55], v4 offset:0
  s_waitcnt lgkmcnt(0)
  v_mfma_f32_32x32x16_bf16 v[128:143], a[52:55], a[4:7], v[128:143]
  ds_read_b128 a[56:59], v5 offset:0
  s_waitcnt lgkmcnt(0)
  v_mfma_f32_32x32x16_bf16 v[128:143], a[56:59], a[8:11], v[128:143]
  ds_read_b128 a[60:63], v6 offset:0
  s_waitcnt lgkmcnt(0)
  v_mfma_f32_32x32x16_bf16 v[128:143], a[60:63], a[12:15], v[128:143]
  ds_read_b128 a[64:67], v3 offset:4096
  s_waitcnt lgkmcnt(0)
  v_mfma_f32_32x32x16_bf16 v[128:143], a[64:67], a[16:19], v[128:143]
  ds_read_b128 a[68:71], v4 offset:4096
  s_waitcnt lgkmcnt(0)
  v_mfma_f32_32x32x16_bf16 v[128:143], a[68:71], a[20:23], v[128:143]
  ds_read_b128 a[72:75], v5 offset:4096
  s_waitcnt lgkmcnt(0)
  v_mfma_f32_32x32x16_bf16 v[128:143], a[72:75], a[24:27], v[128:143]
  ds_read_b128 a[76:79], v6 offset:4096
  s_waitcnt lgkmcnt(0)
  v_mfma_f32_32x32x16_bf16 v[128:143], a[76:79], a[28:31], v[128:143]
  ds_read_b128 a[48:51], v3 offset:8192
  s_waitcnt lgkmcnt(0)
  v_mfma_f32_32x32x16_bf16 v[128:143], a[48:51], a[32:35], v[128:143]
  ds_read_b128 a[52:55], v4 offset:8192
  s_waitcnt lgkmcnt(0)
  v_mfma_f32_32x32x16_bf16 v[128:143], a[52:55], a[36:39], v[128:143]
  ds_read_b128 a[56:59], v5 offset:8192
  s_waitcnt lgkmcnt(0)
  v_mfma_f32_32x32x16_bf16 v[128:143], a[56:59], a[40:43], v[128:143]
  ds_read_b128 a[60:63], v6 offset:8192
  s_waitcnt lgkmcnt(0)
  v_mfma_f32_32x32x16_bf16 v[128:143], a[60:63], a[44:47], v[128:143]
  s_nop 11
  v_max3_f32 v26, v128, v129, v26
  v_max3_f32 v26, v130, v131, v26
  v_max3_f32 v26, v132, v133, v26
  v_max3_f32 v26, v134, v135, v26
  v_max3_f32 v26, v136, v137, v26
  v_max3_f32 v26, v138, v139, v26
  v_max3_f32 v26, v140, v141, v26
  v_max3_f32 v26, v142, v143, v26
  s_add_u32 s23, s23, 1
  s_cmp_lt_u32 s23, 8
  s_cbranch_scc1 ts_b_fbl
  s_nop 4
  v_mov_b32 v27, v26
  s_nop 1
  v_permlane32_swap_b32 v26, v27
  v_max_f32 v26, v26, v27
  s_lshl_b32 s17, s12, 2
  v_add_u32 v27, s17, v11
  v_subrev_u32 v27, 40960, v27
  ds_write_b32 v27, v26
  s_waitcnt lgkmcnt(0)
  s_barrier
  v_subrev_u32 v27, 40960, v11
  ds_read_b128 v[192:195], v27
  s_waitcnt lgkmcnt(0)
  v_max_f32 v192, v192, v193
  v_max3_f32 v192, v194, v195, v192
  v_sub_f32 v160, 0, v192
  v_mov_b32 v161, v160
  v_mov_b32 v162, v160
  v_mov_b32 v163, v160
  v_mov_b32 v164, v160
  v_mov_b32 v165, v160
  v_mov_b32 v166, v160
  v_mov_b32 v167, v160
  v_mov_b32 v168, v160
  v_mov_b32 v169, v160
  v_mov_b32 v170, v160
  v_mov_b32 v171, v160
  v_mov_b32 v172, v160
  v_mov_b32 v173, v160
  v_mov_b32 v174, v160
  v_mov_b32 v175, v160
  s_add_u32 m0, s16, 0
  s_nop 0
  buffer_load_dwordx4 v2, s[4:7], s24 offen offset:0 sc1 lds
  buffer_load_dwordx4 v2, s[4:7], s24 offen offset:1024 sc1 lds
  buffer_load_dwordx4 v2, s[4:7], s24 offen offset:2048 sc1 lds
  buffer_load_dwordx4 v2, s[4:7], s24 offen offset:3072 sc1 lds
  s_add_u32 m0, s16, 4096
  s_nop 0
  buffer_load_dwordx4 v2, s[4:7], s25 offen offset:0 sc1 lds
  buffer_load_dwordx4 v2, s[4:7], s25 offen offset:1024 sc1 lds
  buffer_load_dwordx4 v2, s[4:7], s25 offen offset:2048 sc1 lds
  buffer_load_dwordx4 v2, s[4:7], s25 offen offset:3072 sc1 lds
  s_add_u32 m0, s16, 8192
  s_nop 0
  buffer_load_dwordx4 v2, s[4:7], s26 offen offset:0 sc1 lds
  buffer_load_dwordx4 v2, s[4:7], s26 offen offset:1024 sc1 lds
  buffer_load_dwordx4 v2, s[4:7], s26 offen offset:2048 sc1 lds
  buffer_load_dwordx4 v2, s[4:7], s26 offen offset:3072 sc1 lds
  s_add_u32 m0, s16, 12288
  s_nop 0
  buffer_load_dwordx4 v2, s[4:7], s27 offen offset:0 sc1 lds
  buffer_load_dwordx4 v2, s[4:7], s27 offen offset:1024 sc1 lds
  buffer_load_dwordx4 v2, s[4:7], s27 offen offset:2048 sc1 lds
  buffer_load_dwordx4 v2, s[4:7], s27 offen offset:3072 sc1 lds
  s_add_u32 m0, s16, 16384
  s_nop 0
  buffer_load_dwordx4 v2, s[4:7], s28 offen offset:0 sc1 lds
  buffer_load_dwordx4 v2, s[4:7], s28 offen offset:1024 sc1 lds
  buffer_load_dwordx4 v2, s[4:7], s28 offen offset:2048 sc1 lds
  s_waitcnt vmcnt(0) lgkmcnt(0)
  ds_read_b128 a[48:51], v3 offset:0
  ds_read_b128 a[52:55], v4 offset:0
  ds_read_b128 a[56:59], v5 offset:0
  ds_read_b128 a[60:63], v6 offset:0
  ds_read_b128 a[64:67], v3 offset:4096
  ds_read_b128 a[68:71], v4 offset:4096
  s_waitcnt lgkmcnt(0)
  s_nop 4
  s_branch ts_b_go
ts_b_end:
  s_endpgm
.section .rodata,"a"
.p2align 6
.amdhsa_kernel standalone__video_timesformer__vision_kernel
  .amdhsa_next_free_vgpr 508
  .amdhsa_next_free_sgpr 102
  .amdhsa_accum_offset 252
  .amdhsa_group_segment_fixed_size 0
  .amdhsa_kernarg_size 64
  .amdhsa_user_sgpr_count 2
  .amdhsa_user_sgpr_kernarg_segment_ptr 1
  .amdhsa_system_sgpr_workgroup_id_x 1
.end_amdhsa_kernel
```
